```python
import torch

def _softmax(x, axis=-1):
    return torch.softmax(x, dim=axis)
def _gelu(x):
    return torch.nn.functional.gelu(x, approximate="tanh")
def _silu(x):
    return torch.nn.functional.silu(x)
def _sigmoid(x):
    return torch.sigmoid(x)
def _layernorm(x, axis=-1, eps=1e-5):
    m = x.mean(dim=axis, keepdim=True)
    v = x.var(dim=axis, keepdim=True, unbiased=False)
    return (x - m) / torch.sqrt(v + eps)
def _scatter_add(tgt, idx, src, axis=0):
    return tgt.clone().index_add_(axis, idx, src)
def _segment_sum(src, seg, n):
    out = torch.zeros((n,) + src.shape[1:], dtype=src.dtype)
    return out.index_add_(0, seg, src)
def _pad(x, pw):
    flat = tuple(v for pair in reversed(pw) for v in pair)
    return torch.nn.functional.pad(x, flat)

kernel_name = 'recurrent_scan__sliding_block_cached__dense_activation_gelu__decode'

def setup_inputs():

    _w = (lambda a: (lambda t: t.to(torch.bfloat16) if t.is_floating_point() else t)(torch.as_tensor(a)))
    def _A_setup():
        B, Sq, D = 1, 1, 640
        Hq, Hkv, Sk, Dh = 32, 32, 4096, 128
        assert Hq % Hkv == 0, (Hq, Hkv)
        return {
            "x": _w((lambda *s: torch.randn(*s, dtype=torch.bfloat16) * 0.05)(B, Sq, D)),
            "k_cache": _w((lambda *s: torch.randn(*s, dtype=torch.bfloat16) * 3.2)(B, Hkv, Sk, Dh)),
            "v_cache": _w((lambda *s: torch.randn(*s, dtype=torch.bfloat16) * 3.2)(B, Hkv, Sk, Dh)),
            "wq": _w((lambda *s: torch.randn(*s, dtype=torch.bfloat16) * 3.2)(D, Hq * Dh) * (D ** -0.5)),
            "wo": _w((lambda *s: torch.randn(*s, dtype=torch.bfloat16) * 3.2)(Hq * Dh, D) * ((Hq * Dh) ** -0.5)),
        }
    _A_in = _A_setup()

    def _B_setup():
        B, S, D, F = 1, 1, 640, 1728
        return {
            "x": _w((lambda *s: torch.randn(*s, dtype=torch.bfloat16) * 0.05)(B, S, D)),
            "w1": _w((lambda *s: torch.randn(*s, dtype=torch.bfloat16) * 3.2)(D, F) * (D ** -0.5)),
            "b1": _w((lambda *s: torch.randn(*s, dtype=torch.bfloat16) * 3.2)(F) * 0.01),
            "w2": _w((lambda *s: torch.randn(*s, dtype=torch.bfloat16) * 0.4)(F, D) * (F ** -0.5)),
            "b2": _w((lambda *s: torch.randn(*s, dtype=torch.bfloat16) * 0.4)(D) * 0.01),
        }
    _B_in = _B_setup()

    return {
        "A_x": _A_in["x"],
        "A_k_cache": _A_in["k_cache"],
        "A_v_cache": _A_in["v_cache"],
        "A_wq": _A_in["wq"],
        "A_wo": _A_in["wo"],
        "B_x": _B_in["x"],
        "B_w1": _B_in["w1"],
        "B_b1": _B_in["b1"],
        "B_w2": _B_in["w2"],
        "B_b2": _B_in["b2"],
    }

def reference(A_x, A_k_cache, A_v_cache, A_wq, A_wo, B_x, B_w1, B_b1, B_w2, B_b2):
    def _A_ref(x, k_cache, v_cache, wq, wo):
        B, Sq, D = x.shape
        Hq, Dh = 32, 128
        Hkv, Sk = k_cache.shape[1], k_cache.shape[2]
        W = min(4096, max(256, Sk // 4))
        rep = Hq // Hkv
        q = (lambda x, *d: x.permute(*d))((x @ wq).reshape(B, Sq, Hq, Dh), 0, 2, 1, 3)
        k = (lambda x, n, axis: torch.repeat_interleave(x, n, dim=axis))(k_cache[:, :, Sk - W:, :], rep, axis=1)
        v = (lambda x, n, axis: torch.repeat_interleave(x, n, dim=axis))(v_cache[:, :, Sk - W:, :], rep, axis=1)
        scores = torch.einsum("bhqd,bhkd->bhqk", q, k) * (Dh ** -0.5)
        p = _softmax(scores, axis=-1)
        o = torch.einsum("bhqk,bhkd->bhqd", p, v)
        return (lambda x, *d: x.permute(*d))(o, 0, 2, 1, 3).reshape(B, Sq, Hq * Dh) @ wo

    def _B_ref(x, w1, b1, w2, b2):
        h = torch.einsum("bsd,df->bsf", x, w1) + b1
        h = _gelu(h)
        return torch.einsum("bsf,fd->bsd", h, w2) + b2

    x = A_x
    xn = _layernorm(x, axis=-1)
    s = _A_ref(xn, A_k_cache, A_v_cache, A_wq, A_wo)
    g = _silu(_B_ref(xn, B_w1, B_b1, B_w2, B_b2))
    return x + s * g
```

```asm
; @launch grid=(256,1,1) block=(768,1,1) lds=6400
.amdgcn_target "amdgcn-amd-amdhsa--gfx950"
.text
.globl recurrent_scan__sliding_block_cached__dense_activation_gelu__decode_kernel
.p2align 8
.type recurrent_scan__sliding_block_cached__dense_activation_gelu__decode_kernel,@function
recurrent_scan__sliding_block_cached__dense_activation_gelu__decode_kernel:
  s_cmp_ge_u32 s2, 256
  s_cbranch_scc1 L_end
  s_load_dwordx2 s[44:45], s[0:1], 0
  s_load_dwordx2 s[84:85], s[0:1], 96
  v_lshrrev_b32 v24, 6, v0
  v_and_b32 v1, 63, v0
  s_and_b32 s3, s2, 31
  v_readfirstlane_b32 s5, v24
  s_lshr_b32 s4, s2, 5
  v_lshlrev_b32 v2, 4, v1
  v_lshrrev_b32 v24, 4, v1
  v_and_b32 v25, 15, v1
  v_mov_b32 v18, 0
  s_cmp_ge_u32 s5, 2
  s_cbranch_scc1 L_notfront
  s_mul_i32 s7, s4, 80
  s_cmp_eq_u32 s5, 0
  s_cbranch_scc0 L_role_h0
  s_load_dwordx2 s[56:57], s[0:1], 24
  s_setprio 3
  s_lshl_b32 s25, s7, 1
  v_lshlrev_b32 v7, 2, v1
  v_lshl_add_u32 v6, v25, 2, v24
  v_lshlrev_b32 v3, 13, v24
  v_lshlrev_b32 v6, 1, v6
  v_lshl_add_u32 v3, v25, 4, v3
  s_lshl_b32 s16, s7, 13
  s_lshl_b32 s9, s3, 8
  s_add_u32 s16, s16, s9
  s_mov_b32 s46, 1280
  s_mov_b32 s47, 0x20000
  s_mov_b32 s86, 1544192
  s_mov_b32 s87, 0x20000
  s_mov_b32 s58, 5242880
  s_mov_b32 s59, 0x20000
  s_waitcnt lgkmcnt(0)
  buffer_load_dwordx4 v[32:35], v2, s[44:47], 0 offen
  buffer_load_dword v31, v7, s[44:47], 0 offen offset:1024
  buffer_load_ushort v36, v6, s[44:47], s25 offen
  buffer_load_ushort v37, v6, s[44:47], s25 offen offset:128
  buffer_load_dword v29, v18, s[84:87], 0 offen sc1
  buffer_load_dwordx4 v[76:79], v3, s[56:59], s16 offen nt
  s_add_u32 s16, s16, 32768
  buffer_load_dwordx4 v[80:83], v3, s[56:59], s16 offen nt
  s_add_u32 s16, s16, 32768
  buffer_load_dwordx4 v[84:87], v3, s[56:59], s16 offen nt
  s_add_u32 s16, s16, 32768
  buffer_load_dwordx4 v[88:91], v3, s[56:59], s16 offen nt
  s_add_u32 s16, s16, 32768
  buffer_load_dwordx4 v[92:95], v3, s[56:59], s16 offen nt
  s_add_u32 s16, s16, 32768
  buffer_load_dwordx4 v[96:99], v3, s[56:59], s16 offen nt
  s_add_u32 s16, s16, 32768
  buffer_load_dwordx4 v[100:103], v3, s[56:59], s16 offen nt
  s_add_u32 s16, s16, 32768
  buffer_load_dwordx4 v[104:107], v3, s[56:59], s16 offen nt
  s_add_u32 s16, s16, 32768
  buffer_load_dwordx4 v[108:111], v3, s[56:59], s16 offen nt
  s_add_u32 s16, s16, 32768
  buffer_load_dwordx4 v[112:115], v3, s[56:59], s16 offen nt
  s_add_u32 s16, s16, 32768
  buffer_load_dwordx4 v[116:119], v3, s[56:59], s16 offen nt
  s_add_u32 s16, s16, 32768
  buffer_load_dwordx4 v[120:123], v3, s[56:59], s16 offen nt
  s_add_u32 s16, s16, 32768
  buffer_load_dwordx4 v[124:127], v3, s[56:59], s16 offen nt
  s_add_u32 s16, s16, 32768
  buffer_load_dwordx4 v[128:131], v3, s[56:59], s16 offen nt
  s_add_u32 s16, s16, 32768
  buffer_load_dwordx4 v[132:135], v3, s[56:59], s16 offen nt
  s_add_u32 s16, s16, 32768
  buffer_load_dwordx4 v[136:139], v3, s[56:59], s16 offen nt
  s_add_u32 s16, s16, 32768
  buffer_load_dwordx4 v[140:143], v3, s[56:59], s16 offen nt
  s_add_u32 s16, s16, 32768
  buffer_load_dwordx4 v[144:147], v3, s[56:59], s16 offen nt
  s_add_u32 s16, s16, 32768
  buffer_load_dwordx4 v[148:151], v3, s[56:59], s16 offen nt
  s_add_u32 s16, s16, 32768
  buffer_load_dwordx4 v[152:155], v3, s[56:59], s16 offen nt
  v_lshlrev_b32 v19, 6, v25
  v_lshl_add_u32 v19, v24, 4, v19
  s_lshl_b32 s30, s3, 13
  s_lshl_b32 s9, s4, 10
  s_add_u32 s30, s30, s9
  s_add_u32 s30, s30, 4096
  s_branch L_ln
L_role_h0:
  s_load_dwordx2 s[64:65], s[0:1], 48
  s_load_dwordx2 s[68:69], s[0:1], 56
  s_load_dwordx2 s[72:73], s[0:1], 64
  s_setprio 3
  s_lshl_b32 s25, s7, 1
  v_lshlrev_b32 v7, 2, v1
  v_lshl_add_u32 v6, v25, 2, v24
  v_mul_u32_u24 v3, 3456, v24
  v_lshlrev_b32 v6, 1, v6
  v_lshl_add_u32 v3, v25, 3, v3
  s_cmp_lt_u32 s3, 27
  s_cselect_b32 s35, 1, 0
  s_cselect_b32 s39, 0, 2130706432
  s_mul_i32 s16, s7, 3456
  s_lshl_b32 s9, s3, 7
  s_add_u32 s16, s16, s9
  s_add_u32 s16, s16, s39
  s_mov_b32 s46, 1280
  s_mov_b32 s47, 0x20000
  s_mov_b32 s86, 1544192
  s_mov_b32 s87, 0x20000
  s_mov_b32 s66, 2211840
  s_mov_b32 s67, 0x20000
  s_waitcnt lgkmcnt(0)
  buffer_load_dwordx4 v[32:35], v2, s[44:47], 0 offen
  buffer_load_dword v31, v7, s[44:47], 0 offen offset:1024
  buffer_load_ushort v36, v6, s[44:47], s25 offen
  buffer_load_ushort v37, v6, s[44:47], s25 offen offset:128
  buffer_load_dword v29, v18, s[84:87], 0 offen sc1
  buffer_load_dwordx2 v[76:77], v3, s[64:67], s16 offen nt
  s_add_u32 s16, s16, 13824
  buffer_load_dwordx2 v[78:79], v3, s[64:67], s16 offen nt
  s_add_u32 s16, s16, 13824
  buffer_load_dwordx2 v[80:81], v3, s[64:67], s16 offen nt
  s_add_u32 s16, s16, 13824
  buffer_load_dwordx2 v[82:83], v3, s[64:67], s16 offen nt
  s_add_u32 s16, s16, 13824
  buffer_load_dwordx2 v[84:85], v3, s[64:67], s16 offen nt
  s_add_u32 s16, s16, 13824
  buffer_load_dwordx2 v[86:87], v3, s[64:67], s16 offen nt
  s_add_u32 s16, s16, 13824
  buffer_load_dwordx2 v[88:89], v3, s[64:67], s16 offen nt
  s_add_u32 s16, s16, 13824
  buffer_load_dwordx2 v[90:91], v3, s[64:67], s16 offen nt
  s_add_u32 s16, s16, 13824
  buffer_load_dwordx2 v[92:93], v3, s[64:67], s16 offen nt
  s_add_u32 s16, s16, 13824
  buffer_load_dwordx2 v[94:95], v3, s[64:67], s16 offen nt
  s_add_u32 s16, s16, 13824
  buffer_load_dwordx2 v[96:97], v3, s[64:67], s16 offen nt
  s_add_u32 s16, s16, 13824
  buffer_load_dwordx2 v[98:99], v3, s[64:67], s16 offen nt
  s_add_u32 s16, s16, 13824
  buffer_load_dwordx2 v[100:101], v3, s[64:67], s16 offen nt
  s_add_u32 s16, s16, 13824
  buffer_load_dwordx2 v[102:103], v3, s[64:67], s16 offen nt
  s_add_u32 s16, s16, 13824
  buffer_load_dwordx2 v[104:105], v3, s[64:67], s16 offen nt
  s_add_u32 s16, s16, 13824
  buffer_load_dwordx2 v[106:107], v3, s[64:67], s16 offen nt
  s_add_u32 s16, s16, 13824
  buffer_load_dwordx2 v[108:109], v3, s[64:67], s16 offen nt
  s_add_u32 s16, s16, 13824
  buffer_load_dwordx2 v[110:111], v3, s[64:67], s16 offen nt
  s_add_u32 s16, s16, 13824
  buffer_load_dwordx2 v[112:113], v3, s[64:67], s16 offen nt
  s_add_u32 s16, s16, 13824
  buffer_load_dwordx2 v[114:115], v3, s[64:67], s16 offen nt
  s_mov_b32 s70, 3456
  s_mov_b32 s71, 0x20000
  s_mov_b32 s74, 2211840
  s_mov_b32 s75, 0x20000
  v_lshl_add_u32 v19, v25, 2, v24
  v_lshlrev_b32 v19, 3, v19
  s_lshl_b32 s30, s3, 12
  s_lshl_b32 s9, s4, 9
  s_add_u32 s30, s30, s9
  s_add_u32 s30, s30, 266240
L_ln:
  v_mov_b32 v30, 1
  s_mov_b32 s11, 0
  s_barrier
  v_mov_b32 v40, 0
  v_mov_b32 v41, 0
  v_mov_b32 v42, 0
  v_mov_b32 v43, 0
  v_mov_b32 v44, 0
  v_mov_b32 v45, 0
  v_mov_b32 v46, 0
  v_mov_b32 v47, 0
  v_mov_b32 v28, 0x3f803f80
  v_mov_b32 v24, 0
  s_waitcnt vmcnt(20)
  v_readfirstlane_b32 s6, v29
  v_dot2c_f32_bf16 v24, v32, v28
  v_dot2c_f32_bf16 v24, v33, v28
  v_dot2c_f32_bf16 v24, v34, v28
  v_dot2c_f32_bf16 v24, v35, v28
  v_dot2c_f32_bf16 v24, v31, v28
  v_lshlrev_b32 v156, 16, v32
  v_and_b32 v157, 0xffff0000, v32
  v_lshlrev_b32 v158, 16, v33
  v_and_b32 v159, 0xffff0000, v33
  v_lshlrev_b32 v160, 16, v34
  v_and_b32 v161, 0xffff0000, v34
  v_lshlrev_b32 v162, 16, v35
  v_and_b32 v163, 0xffff0000, v35
  v_lshlrev_b32 v164, 16, v31
  v_and_b32 v165, 0xffff0000, v31
  s_add_u32 s6, s6, 2654435769
  v_add_f32_dpp v24, v24, v24 row_ror:8 row_mask:0xf bank_mask:0xf
  s_nop 1
  v_add_f32_dpp v24, v24, v24 row_ror:4 row_mask:0xf bank_mask:0xf
  s_nop 1
  v_add_f32_dpp v24, v24, v24 row_ror:2 row_mask:0xf bank_mask:0xf
  s_nop 1
  v_add_f32_dpp v24, v24, v24 row_ror:1 row_mask:0xf bank_mask:0xf
  v_mov_b32 v25, v24
  s_nop 1
  v_permlane16_swap_b32 v24, v25
  v_add_f32 v24, v24, v25
  v_mov_b32 v25, v24
  s_nop 1
  v_permlane32_swap_b32 v24, v25
  v_add_f32 v24, v24, v25
  v_mul_f32 v24, 0x3acccccd, v24
  v_sub_f32 v156, v156, v24
  v_sub_f32 v157, v157, v24
  v_sub_f32 v158, v158, v24
  v_sub_f32 v159, v159, v24
  v_sub_f32 v160, v160, v24
  v_sub_f32 v161, v161, v24
  v_sub_f32 v162, v162, v24
  v_sub_f32 v163, v163, v24
  v_sub_f32 v164, v164, v24
  v_sub_f32 v165, v165, v24
  v_mul_f32 v26, v156, v156
  v_mul_f32 v27, v157, v157
  v_fmac_f32 v26, v158, v158
  v_fmac_f32 v27, v159, v159
  v_fmac_f32 v26, v160, v160
  v_fmac_f32 v27, v161, v161
  v_fmac_f32 v26, v162, v162
  v_fmac_f32 v27, v163, v163
  v_fmac_f32 v26, v164, v164
  v_fmac_f32 v27, v165, v165
  v_add_f32 v26, v26, v27
  v_cvt_pk_bf16_f32 v24, v24, v24
  v_and_b32 v24, 0xffff0000, v24
  v_add_f32_dpp v26, v26, v26 row_ror:8 row_mask:0xf bank_mask:0xf
  v_lshlrev_b32 v36, 16, v36
  v_lshlrev_b32 v37, 16, v37
  v_add_f32_dpp v26, v26, v26 row_ror:4 row_mask:0xf bank_mask:0xf
  v_sub_f32 v36, v36, v24
  v_sub_f32 v37, v37, v24
  v_add_f32_dpp v26, v26, v26 row_ror:2 row_mask:0xf bank_mask:0xf
  v_cvt_pk_bf16_f32 v36, v36, v36
  v_cvt_pk_bf16_f32 v37, v37, v37
  v_add_f32_dpp v26, v26, v26 row_ror:1 row_mask:0xf bank_mask:0xf
  v_and_b32 v36, 0xffff0000, v36
  v_mov_b32 v25, v26
  v_and_b32 v37, 0xffff0000, v37
  s_nop 0
  v_permlane16_swap_b32 v26, v25
  v_add_f32 v26, v26, v25
  v_mov_b32 v25, v26
  s_nop 1
  v_permlane32_swap_b32 v26, v25
  v_add_f32 v26, v26, v25
  v_mul_f32 v26, 0x3acccccd, v26
  v_cvt_pk_bf16_f32 v26, v26, v26
  v_and_b32 v26, 0xffff0000, v26
  v_add_f32 v26, 0x3727c5ac, v26
  v_cvt_pk_bf16_f32 v26, v26, v26
  v_and_b32 v26, 0xffff0000, v26
  v_sqrt_f32 v26, v26
  s_nop 0
  v_cvt_pk_bf16_f32 v26, v26, v26
  v_and_b32 v26, 0xffff0000, v26
  v_rcp_f32 v26, v26
  s_nop 0
  v_mul_f32 v36, v36, v26
  v_mul_f32 v37, v37, v26
  v_cvt_pk_bf16_f32 v36, v36, v36
  v_cvt_pk_bf16_f32 v37, v37, v37
  v_and_b32 v38, 0xffff0000, v36
  v_and_b32 v39, 0xffff0000, v37
  v_and_b32 v36, 0xffff, v36
  v_and_b32 v37, 0xffff, v37
  v_mov_b32 v25, s6
  v_mov_b32 v27, s6
  s_cmp_eq_u32 s5, 0
  s_cbranch_scc0 L_role_h1
  s_waitcnt vmcnt(19)
  v_dot2c_f32_bf16_dpp v40, v36, v76 row_newbcast:0 row_mask:0xf bank_mask:0xf
  v_dot2c_f32_bf16_dpp v41, v38, v76 row_newbcast:0 row_mask:0xf bank_mask:0xf
  v_dot2c_f32_bf16_dpp v42, v36, v77 row_newbcast:0 row_mask:0xf bank_mask:0xf
  v_dot2c_f32_bf16_dpp v43, v38, v77 row_newbcast:0 row_mask:0xf bank_mask:0xf
  v_dot2c_f32_bf16_dpp v44, v36, v78 row_newbcast:0 row_mask:0xf bank_mask:0xf
  v_dot2c_f32_bf16_dpp v45, v38, v78 row_newbcast:0 row_mask:0xf bank_mask:0xf
  v_dot2c_f32_bf16_dpp v46, v36, v79 row_newbcast:0 row_mask:0xf bank_mask:0xf
  v_dot2c_f32_bf16_dpp v47, v38, v79 row_newbcast:0 row_mask:0xf bank_mask:0xf
  s_waitcnt vmcnt(18)
  v_dot2c_f32_bf16_dpp v40, v36, v80 row_newbcast:1 row_mask:0xf bank_mask:0xf
  v_dot2c_f32_bf16_dpp v41, v38, v80 row_newbcast:1 row_mask:0xf bank_mask:0xf
  v_dot2c_f32_bf16_dpp v42, v36, v81 row_newbcast:1 row_mask:0xf bank_mask:0xf
  v_dot2c_f32_bf16_dpp v43, v38, v81 row_newbcast:1 row_mask:0xf bank_mask:0xf
  v_dot2c_f32_bf16_dpp v44, v36, v82 row_newbcast:1 row_mask:0xf bank_mask:0xf
  v_dot2c_f32_bf16_dpp v45, v38, v82 row_newbcast:1 row_mask:0xf bank_mask:0xf
  v_dot2c_f32_bf16_dpp v46, v36, v83 row_newbcast:1 row_mask:0xf bank_mask:0xf
  v_dot2c_f32_bf16_dpp v47, v38, v83 row_newbcast:1 row_mask:0xf bank_mask:0xf
  s_waitcnt vmcnt(17)
  v_dot2c_f32_bf16_dpp v40, v36, v84 row_newbcast:2 row_mask:0xf bank_mask:0xf
  v_dot2c_f32_bf16_dpp v41, v38, v84 row_newbcast:2 row_mask:0xf bank_mask:0xf
  v_dot2c_f32_bf16_dpp v42, v36, v85 row_newbcast:2 row_mask:0xf bank_mask:0xf
  v_dot2c_f32_bf16_dpp v43, v38, v85 row_newbcast:2 row_mask:0xf bank_mask:0xf
  v_dot2c_f32_bf16_dpp v44, v36, v86 row_newbcast:2 row_mask:0xf bank_mask:0xf
  v_dot2c_f32_bf16_dpp v45, v38, v86 row_newbcast:2 row_mask:0xf bank_mask:0xf
  v_dot2c_f32_bf16_dpp v46, v36, v87 row_newbcast:2 row_mask:0xf bank_mask:0xf
  v_dot2c_f32_bf16_dpp v47, v38, v87 row_newbcast:2 row_mask:0xf bank_mask:0xf
  s_waitcnt vmcnt(16)
  v_dot2c_f32_bf16_dpp v40, v36, v88 row_newbcast:3 row_mask:0xf bank_mask:0xf
  v_dot2c_f32_bf16_dpp v41, v38, v88 row_newbcast:3 row_mask:0xf bank_mask:0xf
  v_dot2c_f32_bf16_dpp v42, v36, v89 row_newbcast:3 row_mask:0xf bank_mask:0xf
  v_dot2c_f32_bf16_dpp v43, v38, v89 row_newbcast:3 row_mask:0xf bank_mask:0xf
  v_dot2c_f32_bf16_dpp v44, v36, v90 row_newbcast:3 row_mask:0xf bank_mask:0xf
  v_dot2c_f32_bf16_dpp v45, v38, v90 row_newbcast:3 row_mask:0xf bank_mask:0xf
  v_dot2c_f32_bf16_dpp v46, v36, v91 row_newbcast:3 row_mask:0xf bank_mask:0xf
  v_dot2c_f32_bf16_dpp v47, v38, v91 row_newbcast:3 row_mask:0xf bank_mask:0xf
  s_waitcnt vmcnt(15)
  v_dot2c_f32_bf16_dpp v40, v36, v92 row_newbcast:4 row_mask:0xf bank_mask:0xf
  v_dot2c_f32_bf16_dpp v41, v38, v92 row_newbcast:4 row_mask:0xf bank_mask:0xf
  v_dot2c_f32_bf16_dpp v42, v36, v93 row_newbcast:4 row_mask:0xf bank_mask:0xf
  v_dot2c_f32_bf16_dpp v43, v38, v93 row_newbcast:4 row_mask:0xf bank_mask:0xf
  v_dot2c_f32_bf16_dpp v44, v36, v94 row_newbcast:4 row_mask:0xf bank_mask:0xf
  v_dot2c_f32_bf16_dpp v45, v38, v94 row_newbcast:4 row_mask:0xf bank_mask:0xf
  v_dot2c_f32_bf16_dpp v46, v36, v95 row_newbcast:4 row_mask:0xf bank_mask:0xf
  v_dot2c_f32_bf16_dpp v47, v38, v95 row_newbcast:4 row_mask:0xf bank_mask:0xf
  s_waitcnt vmcnt(14)
  v_dot2c_f32_bf16_dpp v40, v36, v96 row_newbcast:5 row_mask:0xf bank_mask:0xf
  v_dot2c_f32_bf16_dpp v41, v38, v96 row_newbcast:5 row_mask:0xf bank_mask:0xf
  v_dot2c_f32_bf16_dpp v42, v36, v97 row_newbcast:5 row_mask:0xf bank_mask:0xf
  v_dot2c_f32_bf16_dpp v43, v38, v97 row_newbcast:5 row_mask:0xf bank_mask:0xf
  v_dot2c_f32_bf16_dpp v44, v36, v98 row_newbcast:5 row_mask:0xf bank_mask:0xf
  v_dot2c_f32_bf16_dpp v45, v38, v98 row_newbcast:5 row_mask:0xf bank_mask:0xf
  v_dot2c_f32_bf16_dpp v46, v36, v99 row_newbcast:5 row_mask:0xf bank_mask:0xf
  v_dot2c_f32_bf16_dpp v47, v38, v99 row_newbcast:5 row_mask:0xf bank_mask:0xf
  s_waitcnt vmcnt(13)
  v_dot2c_f32_bf16_dpp v40, v36, v100 row_newbcast:6 row_mask:0xf bank_mask:0xf
  v_dot2c_f32_bf16_dpp v41, v38, v100 row_newbcast:6 row_mask:0xf bank_mask:0xf
  v_dot2c_f32_bf16_dpp v42, v36, v101 row_newbcast:6 row_mask:0xf bank_mask:0xf
  v_dot2c_f32_bf16_dpp v43, v38, v101 row_newbcast:6 row_mask:0xf bank_mask:0xf
  v_dot2c_f32_bf16_dpp v44, v36, v102 row_newbcast:6 row_mask:0xf bank_mask:0xf
  v_dot2c_f32_bf16_dpp v45, v38, v102 row_newbcast:6 row_mask:0xf bank_mask:0xf
  v_dot2c_f32_bf16_dpp v46, v36, v103 row_newbcast:6 row_mask:0xf bank_mask:0xf
  v_dot2c_f32_bf16_dpp v47, v38, v103 row_newbcast:6 row_mask:0xf bank_mask:0xf
  s_waitcnt vmcnt(12)
  v_dot2c_f32_bf16_dpp v40, v36, v104 row_newbcast:7 row_mask:0xf bank_mask:0xf
  v_dot2c_f32_bf16_dpp v41, v38, v104 row_newbcast:7 row_mask:0xf bank_mask:0xf
  v_dot2c_f32_bf16_dpp v42, v36, v105 row_newbcast:7 row_mask:0xf bank_mask:0xf
  v_dot2c_f32_bf16_dpp v43, v38, v105 row_newbcast:7 row_mask:0xf bank_mask:0xf
  v_dot2c_f32_bf16_dpp v44, v36, v106 row_newbcast:7 row_mask:0xf bank_mask:0xf
  v_dot2c_f32_bf16_dpp v45, v38, v106 row_newbcast:7 row_mask:0xf bank_mask:0xf
  v_dot2c_f32_bf16_dpp v46, v36, v107 row_newbcast:7 row_mask:0xf bank_mask:0xf
  v_dot2c_f32_bf16_dpp v47, v38, v107 row_newbcast:7 row_mask:0xf bank_mask:0xf
  s_waitcnt vmcnt(11)
  v_dot2c_f32_bf16_dpp v40, v36, v108 row_newbcast:8 row_mask:0xf bank_mask:0xf
  v_dot2c_f32_bf16_dpp v41, v38, v108 row_newbcast:8 row_mask:0xf bank_mask:0xf
  v_dot2c_f32_bf16_dpp v42, v36, v109 row_newbcast:8 row_mask:0xf bank_mask:0xf
  v_dot2c_f32_bf16_dpp v43, v38, v109 row_newbcast:8 row_mask:0xf bank_mask:0xf
  v_dot2c_f32_bf16_dpp v44, v36, v110 row_newbcast:8 row_mask:0xf bank_mask:0xf
  v_dot2c_f32_bf16_dpp v45, v38, v110 row_newbcast:8 row_mask:0xf bank_mask:0xf
  v_dot2c_f32_bf16_dpp v46, v36, v111 row_newbcast:8 row_mask:0xf bank_mask:0xf
  v_dot2c_f32_bf16_dpp v47, v38, v111 row_newbcast:8 row_mask:0xf bank_mask:0xf
  s_waitcnt vmcnt(10)
  v_dot2c_f32_bf16_dpp v40, v36, v112 row_newbcast:9 row_mask:0xf bank_mask:0xf
  v_dot2c_f32_bf16_dpp v41, v38, v112 row_newbcast:9 row_mask:0xf bank_mask:0xf
  v_dot2c_f32_bf16_dpp v42, v36, v113 row_newbcast:9 row_mask:0xf bank_mask:0xf
  v_dot2c_f32_bf16_dpp v43, v38, v113 row_newbcast:9 row_mask:0xf bank_mask:0xf
  v_dot2c_f32_bf16_dpp v44, v36, v114 row_newbcast:9 row_mask:0xf bank_mask:0xf
  v_dot2c_f32_bf16_dpp v45, v38, v114 row_newbcast:9 row_mask:0xf bank_mask:0xf
  v_dot2c_f32_bf16_dpp v46, v36, v115 row_newbcast:9 row_mask:0xf bank_mask:0xf
  v_dot2c_f32_bf16_dpp v47, v38, v115 row_newbcast:9 row_mask:0xf bank_mask:0xf
  s_waitcnt vmcnt(9)
  v_dot2c_f32_bf16_dpp v40, v36, v116 row_newbcast:10 row_mask:0xf bank_mask:0xf
  v_dot2c_f32_bf16_dpp v41, v38, v116 row_newbcast:10 row_mask:0xf bank_mask:0xf
  v_dot2c_f32_bf16_dpp v42, v36, v117 row_newbcast:10 row_mask:0xf bank_mask:0xf
  v_dot2c_f32_bf16_dpp v43, v38, v117 row_newbcast:10 row_mask:0xf bank_mask:0xf
  v_dot2c_f32_bf16_dpp v44, v36, v118 row_newbcast:10 row_mask:0xf bank_mask:0xf
  v_dot2c_f32_bf16_dpp v45, v38, v118 row_newbcast:10 row_mask:0xf bank_mask:0xf
  v_dot2c_f32_bf16_dpp v46, v36, v119 row_newbcast:10 row_mask:0xf bank_mask:0xf
  v_dot2c_f32_bf16_dpp v47, v38, v119 row_newbcast:10 row_mask:0xf bank_mask:0xf
  s_waitcnt vmcnt(8)
  v_dot2c_f32_bf16_dpp v40, v36, v120 row_newbcast:11 row_mask:0xf bank_mask:0xf
  v_dot2c_f32_bf16_dpp v41, v38, v120 row_newbcast:11 row_mask:0xf bank_mask:0xf
  v_dot2c_f32_bf16_dpp v42, v36, v121 row_newbcast:11 row_mask:0xf bank_mask:0xf
  v_dot2c_f32_bf16_dpp v43, v38, v121 row_newbcast:11 row_mask:0xf bank_mask:0xf
  v_dot2c_f32_bf16_dpp v44, v36, v122 row_newbcast:11 row_mask:0xf bank_mask:0xf
  v_dot2c_f32_bf16_dpp v45, v38, v122 row_newbcast:11 row_mask:0xf bank_mask:0xf
  v_dot2c_f32_bf16_dpp v46, v36, v123 row_newbcast:11 row_mask:0xf bank_mask:0xf
  v_dot2c_f32_bf16_dpp v47, v38, v123 row_newbcast:11 row_mask:0xf bank_mask:0xf
  s_waitcnt vmcnt(7)
  v_dot2c_f32_bf16_dpp v40, v36, v124 row_newbcast:12 row_mask:0xf bank_mask:0xf
  v_dot2c_f32_bf16_dpp v41, v38, v124 row_newbcast:12 row_mask:0xf bank_mask:0xf
  v_dot2c_f32_bf16_dpp v42, v36, v125 row_newbcast:12 row_mask:0xf bank_mask:0xf
  v_dot2c_f32_bf16_dpp v43, v38, v125 row_newbcast:12 row_mask:0xf bank_mask:0xf
  v_dot2c_f32_bf16_dpp v44, v36, v126 row_newbcast:12 row_mask:0xf bank_mask:0xf
  v_dot2c_f32_bf16_dpp v45, v38, v126 row_newbcast:12 row_mask:0xf bank_mask:0xf
  v_dot2c_f32_bf16_dpp v46, v36, v127 row_newbcast:12 row_mask:0xf bank_mask:0xf
  v_dot2c_f32_bf16_dpp v47, v38, v127 row_newbcast:12 row_mask:0xf bank_mask:0xf
  s_waitcnt vmcnt(6)
  v_dot2c_f32_bf16_dpp v40, v36, v128 row_newbcast:13 row_mask:0xf bank_mask:0xf
  v_dot2c_f32_bf16_dpp v41, v38, v128 row_newbcast:13 row_mask:0xf bank_mask:0xf
  v_dot2c_f32_bf16_dpp v42, v36, v129 row_newbcast:13 row_mask:0xf bank_mask:0xf
  v_dot2c_f32_bf16_dpp v43, v38, v129 row_newbcast:13 row_mask:0xf bank_mask:0xf
  v_dot2c_f32_bf16_dpp v44, v36, v130 row_newbcast:13 row_mask:0xf bank_mask:0xf
  v_dot2c_f32_bf16_dpp v45, v38, v130 row_newbcast:13 row_mask:0xf bank_mask:0xf
  v_dot2c_f32_bf16_dpp v46, v36, v131 row_newbcast:13 row_mask:0xf bank_mask:0xf
  v_dot2c_f32_bf16_dpp v47, v38, v131 row_newbcast:13 row_mask:0xf bank_mask:0xf
  s_waitcnt vmcnt(5)
  v_dot2c_f32_bf16_dpp v40, v36, v132 row_newbcast:14 row_mask:0xf bank_mask:0xf
  v_dot2c_f32_bf16_dpp v41, v38, v132 row_newbcast:14 row_mask:0xf bank_mask:0xf
  v_dot2c_f32_bf16_dpp v42, v36, v133 row_newbcast:14 row_mask:0xf bank_mask:0xf
  v_dot2c_f32_bf16_dpp v43, v38, v133 row_newbcast:14 row_mask:0xf bank_mask:0xf
  v_dot2c_f32_bf16_dpp v44, v36, v134 row_newbcast:14 row_mask:0xf bank_mask:0xf
  v_dot2c_f32_bf16_dpp v45, v38, v134 row_newbcast:14 row_mask:0xf bank_mask:0xf
  v_dot2c_f32_bf16_dpp v46, v36, v135 row_newbcast:14 row_mask:0xf bank_mask:0xf
  v_dot2c_f32_bf16_dpp v47, v38, v135 row_newbcast:14 row_mask:0xf bank_mask:0xf
  s_waitcnt vmcnt(4)
  v_dot2c_f32_bf16_dpp v40, v36, v136 row_newbcast:15 row_mask:0xf bank_mask:0xf
  v_dot2c_f32_bf16_dpp v41, v38, v136 row_newbcast:15 row_mask:0xf bank_mask:0xf
  v_dot2c_f32_bf16_dpp v42, v36, v137 row_newbcast:15 row_mask:0xf bank_mask:0xf
  v_dot2c_f32_bf16_dpp v43, v38, v137 row_newbcast:15 row_mask:0xf bank_mask:0xf
  v_dot2c_f32_bf16_dpp v44, v36, v138 row_newbcast:15 row_mask:0xf bank_mask:0xf
  v_dot2c_f32_bf16_dpp v45, v38, v138 row_newbcast:15 row_mask:0xf bank_mask:0xf
  v_dot2c_f32_bf16_dpp v46, v36, v139 row_newbcast:15 row_mask:0xf bank_mask:0xf
  v_dot2c_f32_bf16_dpp v47, v38, v139 row_newbcast:15 row_mask:0xf bank_mask:0xf
  s_waitcnt vmcnt(3)
  v_dot2c_f32_bf16_dpp v40, v37, v140 row_newbcast:0 row_mask:0xf bank_mask:0xf
  v_dot2c_f32_bf16_dpp v41, v39, v140 row_newbcast:0 row_mask:0xf bank_mask:0xf
  v_dot2c_f32_bf16_dpp v42, v37, v141 row_newbcast:0 row_mask:0xf bank_mask:0xf
  v_dot2c_f32_bf16_dpp v43, v39, v141 row_newbcast:0 row_mask:0xf bank_mask:0xf
  v_dot2c_f32_bf16_dpp v44, v37, v142 row_newbcast:0 row_mask:0xf bank_mask:0xf
  v_dot2c_f32_bf16_dpp v45, v39, v142 row_newbcast:0 row_mask:0xf bank_mask:0xf
  v_dot2c_f32_bf16_dpp v46, v37, v143 row_newbcast:0 row_mask:0xf bank_mask:0xf
  v_dot2c_f32_bf16_dpp v47, v39, v143 row_newbcast:0 row_mask:0xf bank_mask:0xf
  s_waitcnt vmcnt(2)
  v_dot2c_f32_bf16_dpp v40, v37, v144 row_newbcast:1 row_mask:0xf bank_mask:0xf
  v_dot2c_f32_bf16_dpp v41, v39, v144 row_newbcast:1 row_mask:0xf bank_mask:0xf
  v_dot2c_f32_bf16_dpp v42, v37, v145 row_newbcast:1 row_mask:0xf bank_mask:0xf
  v_dot2c_f32_bf16_dpp v43, v39, v145 row_newbcast:1 row_mask:0xf bank_mask:0xf
  v_dot2c_f32_bf16_dpp v44, v37, v146 row_newbcast:1 row_mask:0xf bank_mask:0xf
  v_dot2c_f32_bf16_dpp v45, v39, v146 row_newbcast:1 row_mask:0xf bank_mask:0xf
  v_dot2c_f32_bf16_dpp v46, v37, v147 row_newbcast:1 row_mask:0xf bank_mask:0xf
  v_dot2c_f32_bf16_dpp v47, v39, v147 row_newbcast:1 row_mask:0xf bank_mask:0xf
  s_waitcnt vmcnt(1)
  v_dot2c_f32_bf16_dpp v40, v37, v148 row_newbcast:2 row_mask:0xf bank_mask:0xf
  v_dot2c_f32_bf16_dpp v41, v39, v148 row_newbcast:2 row_mask:0xf bank_mask:0xf
  v_dot2c_f32_bf16_dpp v42, v37, v149 row_newbcast:2 row_mask:0xf bank_mask:0xf
  v_dot2c_f32_bf16_dpp v43, v39, v149 row_newbcast:2 row_mask:0xf bank_mask:0xf
  v_dot2c_f32_bf16_dpp v44, v37, v150 row_newbcast:2 row_mask:0xf bank_mask:0xf
  v_dot2c_f32_bf16_dpp v45, v39, v150 row_newbcast:2 row_mask:0xf bank_mask:0xf
  v_dot2c_f32_bf16_dpp v46, v37, v151 row_newbcast:2 row_mask:0xf bank_mask:0xf
  v_dot2c_f32_bf16_dpp v47, v39, v151 row_newbcast:2 row_mask:0xf bank_mask:0xf
  s_waitcnt vmcnt(0)
  v_dot2c_f32_bf16_dpp v40, v37, v152 row_newbcast:3 row_mask:0xf bank_mask:0xf
  v_dot2c_f32_bf16_dpp v41, v39, v152 row_newbcast:3 row_mask:0xf bank_mask:0xf
  v_dot2c_f32_bf16_dpp v42, v37, v153 row_newbcast:3 row_mask:0xf bank_mask:0xf
  v_dot2c_f32_bf16_dpp v43, v39, v153 row_newbcast:3 row_mask:0xf bank_mask:0xf
  v_dot2c_f32_bf16_dpp v44, v37, v154 row_newbcast:3 row_mask:0xf bank_mask:0xf
  v_dot2c_f32_bf16_dpp v45, v39, v154 row_newbcast:3 row_mask:0xf bank_mask:0xf
  v_dot2c_f32_bf16_dpp v46, v37, v155 row_newbcast:3 row_mask:0xf bank_mask:0xf
  v_dot2c_f32_bf16_dpp v47, v39, v155 row_newbcast:3 row_mask:0xf bank_mask:0xf
  s_nop 2
  v_permlane32_swap_b32 v40, v44
  v_add_f32 v40, v40, v44
  v_permlane32_swap_b32 v42, v46
  v_add_f32 v42, v42, v46
  v_permlane32_swap_b32 v41, v45
  v_add_f32 v41, v41, v45
  v_permlane32_swap_b32 v43, v47
  v_add_f32 v43, v43, v47
  s_nop 0
  v_permlane16_swap_b32 v40, v42
  v_add_f32 v24, v40, v42
  v_permlane16_swap_b32 v41, v43
  v_add_f32 v26, v41, v43
  buffer_store_dwordx4 v[24:27], v19, s[84:87], s30 offen sc1
  s_barrier
  v_lshlrev_b32 v11, 3, v1
  v_lshlrev_b32 v10, 2, v1
  v_lshrrev_b32 v26, 3, v1
  v_and_b32 v27, 7, v1
  v_lshlrev_b32 v15, 12, v26
  v_lshl_add_u32 v15, v27, 4, v15
  s_lshl_b32 s7, s3, 13
  s_add_u32 s26, s7, 4096
  s_add_u32 s30, s26, 4096
  s_lshl_b32 s8, s4, 10
  s_add_u32 s8, s8, s7
  s_add_u32 s32, s8, 397312
  s_add_u32 s16, s3, 5
  s_and_b32 s16, s16, 31
  s_mul_i32 s8, s4, 20480
  s_lshl_b32 s7, s16, 7
  s_add_u32 s34, s8, s7
  s_add_u32 s34, s34, 692224
  s_barrier
  buffer_load_dwordx4 v[76:79], v2, s[84:87], s26 offen offset:0 sc1
  buffer_load_dwordx4 v[80:83], v2, s[84:87], s26 offen offset:1024 sc1
  buffer_load_dwordx4 v[84:87], v2, s[84:87], s26 offen offset:2048 sc1
  buffer_load_dwordx4 v[88:91], v2, s[84:87], s26 offen offset:3072 sc1
  buffer_load_dwordx4 v[92:95], v2, s[84:87], s30 offen offset:0 sc1
  buffer_load_dwordx4 v[96:99], v2, s[84:87], s30 offen offset:1024 sc1
  buffer_load_dwordx4 v[100:103], v2, s[84:87], s30 offen offset:2048 sc1
  buffer_load_dwordx4 v[104:107], v2, s[84:87], s30 offen offset:3072 sc1
  s_barrier
  s_barrier
  s_waitcnt vmcnt(0)
  v_min3_u32 v24, v77, v79, v81
  v_min3_u32 v24, v24, v83, v85
  v_min3_u32 v24, v24, v87, v89
  v_min3_u32 v24, v24, v91, v93
  v_min3_u32 v24, v24, v95, v97
  v_min3_u32 v24, v24, v99, v101
  v_min3_u32 v24, v24, v103, v105
  v_min_u32 v24, v24, v107
  v_max3_u32 v25, v77, v79, v81
  v_max3_u32 v25, v25, v83, v85
  v_max3_u32 v25, v25, v87, v89
  v_max3_u32 v25, v25, v91, v93
  v_max3_u32 v25, v25, v95, v97
  v_max3_u32 v25, v25, v99, v101
  v_max3_u32 v25, v25, v103, v105
  v_max_u32 v25, v25, v107
  v_cmp_ne_u32 vcc, s6, v24
  v_cmp_ne_u32 s[12:13], s6, v25
  s_or_b64 vcc, vcc, s[12:13]
  v_add_f32 v108, v76, v80
  v_add_f32 v109, v84, v88
  v_add_f32 v110, v92, v96
  v_add_f32 v111, v100, v104
  v_add_f32 v112, v78, v82
  v_add_f32 v113, v86, v90
  v_add_f32 v114, v94, v98
  v_add_f32 v115, v102, v106
  v_add_f32 v108, v108, v109
  v_add_f32 v110, v110, v111
  v_add_f32 v112, v112, v113
  v_add_f32 v114, v114, v115
  v_add_f32 v108, v108, v110
  v_add_f32 v112, v112, v114
  v_cvt_pk_bf16_f32 v26, v108, v112
  s_cbranch_vccz L_qok
L_qretry:
  s_add_u32 s11, s11, 256
  s_cmp_gt_u32 s11, 4194304
  s_cbranch_scc1 L_qok
  buffer_load_dwordx4 v[76:79], v2, s[84:87], s26 offen offset:0 sc1
  buffer_load_dwordx4 v[80:83], v2, s[84:87], s26 offen offset:1024 sc1
  buffer_load_dwordx4 v[84:87], v2, s[84:87], s26 offen offset:2048 sc1
  buffer_load_dwordx4 v[88:91], v2, s[84:87], s26 offen offset:3072 sc1
  buffer_load_dwordx4 v[92:95], v2, s[84:87], s30 offen offset:0 sc1
  buffer_load_dwordx4 v[96:99], v2, s[84:87], s30 offen offset:1024 sc1
  buffer_load_dwordx4 v[100:103], v2, s[84:87], s30 offen offset:2048 sc1
  buffer_load_dwordx4 v[104:107], v2, s[84:87], s30 offen offset:3072 sc1
  s_waitcnt vmcnt(0)
  v_min3_u32 v24, v77, v79, v81
  v_min3_u32 v24, v24, v83, v85
  v_min3_u32 v24, v24, v87, v89
  v_min3_u32 v24, v24, v91, v93
  v_min3_u32 v24, v24, v95, v97
  v_min3_u32 v24, v24, v99, v101
  v_min3_u32 v24, v24, v103, v105
  v_min_u32 v24, v24, v107
  v_max3_u32 v25, v77, v79, v81
  v_max3_u32 v25, v25, v83, v85
  v_max3_u32 v25, v25, v87, v89
  v_max3_u32 v25, v25, v91, v93
  v_max3_u32 v25, v25, v95, v97
  v_max3_u32 v25, v25, v99, v101
  v_max3_u32 v25, v25, v103, v105
  v_max_u32 v25, v25, v107
  v_cmp_ne_u32 vcc, s6, v24
  v_cmp_ne_u32 s[12:13], s6, v25
  s_or_b64 vcc, vcc, s[12:13]
  v_add_f32 v108, v76, v80
  v_add_f32 v109, v84, v88
  v_add_f32 v110, v92, v96
  v_add_f32 v111, v100, v104
  v_add_f32 v112, v78, v82
  v_add_f32 v113, v86, v90
  v_add_f32 v114, v94, v98
  v_add_f32 v115, v102, v106
  v_add_f32 v108, v108, v109
  v_add_f32 v110, v110, v111
  v_add_f32 v112, v112, v113
  v_add_f32 v114, v114, v115
  v_add_f32 v108, v108, v110
  v_add_f32 v112, v112, v114
  v_cvt_pk_bf16_f32 v26, v108, v112
  s_cbranch_vccnz L_qretry
L_qok:
  ds_write_b32 v10, v26 offset:4096
L_qok2:
  ds_write_b32 v18, v30 offset:6144
  v_mov_b32 v25, s6
  v_mov_b32 v27, s6
L_sp1:
  ds_read_b32 v28, v18 offset:6148
  s_waitcnt lgkmcnt(0)
  v_readfirstlane_b32 s7, v28
  s_nop 0
  s_cmp_ge_u32 s7, 8
  s_cbranch_scc1 L_sp1_ok
  s_sleep 1
  s_branch L_sp1
L_sp1_ok:
L_wo8:
  ds_read_b32 v28, v18 offset:6156
  ds_read_b64 v[108:109], v11 offset:0
  ds_read_b64 v[110:111], v11 offset:512
  ds_read_b64 v[112:113], v11 offset:1024
  ds_read_b64 v[114:115], v11 offset:1536
  ds_read_b64 v[116:117], v11 offset:2048
  ds_read_b64 v[118:119], v11 offset:2560
  ds_read_b64 v[120:121], v11 offset:3072
  ds_read_b64 v[122:123], v11 offset:3584
  s_waitcnt lgkmcnt(8)
  v_readfirstlane_b32 s7, v28
  s_nop 0
  s_cmp_ge_u32 s7, 8
  s_cbranch_scc1 L_wo8_ok
  s_waitcnt lgkmcnt(0)
  s_branch L_wo8
L_wo8_ok:
  s_waitcnt lgkmcnt(6)
  v_add_f32 v108, v108, v110
  v_add_f32 v109, v109, v111
  s_waitcnt lgkmcnt(4)
  v_add_f32 v112, v112, v114
  v_add_f32 v113, v113, v115
  s_waitcnt lgkmcnt(2)
  v_add_f32 v116, v116, v118
  v_add_f32 v117, v117, v119
  s_waitcnt lgkmcnt(0)
  v_add_f32 v120, v120, v122
  v_add_f32 v121, v121, v123
  v_add_f32 v108, v108, v112
  v_add_f32 v109, v109, v113
  v_add_f32 v116, v116, v120
  v_add_f32 v117, v117, v121
  v_add_f32 v24, v108, v116
  v_add_f32 v26, v109, v117
  buffer_store_dwordx4 v[24:27], v2, s[84:87], s32 offen sc1
  s_mov_b64 exec, 1
  ds_add_u32 v18, v30 offset:6164
  s_mov_b64 exec, -1
  s_mov_b32 exec_hi, 0xff
  v_mov_b32 v25, s6
  v_mov_b32 v27, s6
L_sp2:
  ds_read_b32 v28, v18 offset:6160
  s_waitcnt lgkmcnt(0)
  v_readfirstlane_b32 s7, v28
  s_nop 0
  s_cmp_ge_u32 s7, 1
  s_cbranch_scc1 L_sp2_ok
  s_sleep 1
  s_branch L_sp2
L_sp2_ok:
L_ws2:
  ds_read_b32 v28, v18 offset:6160
  ds_read_b64 v[108:109], v11 offset:4864
  ds_read_b64 v[110:111], v11 offset:5184
  ds_read_b64 v[112:113], v11 offset:5504
  ds_read_b64 v[114:115], v11 offset:5824
  s_waitcnt lgkmcnt(4)
  v_readfirstlane_b32 s7, v28
  s_nop 0
  s_cmp_ge_u32 s7, 2
  s_cbranch_scc1 L_ws2_ok
  s_waitcnt lgkmcnt(0)
  s_branch L_ws2
L_ws2_ok:
  s_waitcnt lgkmcnt(2)
  v_add_f32 v108, v108, v110
  v_add_f32 v109, v109, v111
  s_waitcnt lgkmcnt(0)
  v_add_f32 v112, v112, v114
  v_add_f32 v113, v113, v115
  v_add_f32 v24, v108, v112
  v_add_f32 v26, v109, v113
  buffer_store_dwordx4 v[24:27], v15, s[84:87], s34 offen sc1
  s_mov_b64 exec, -1
  s_mov_b64 exec, 1
  ds_add_u32 v18, v30 offset:6172
  s_mov_b64 exec, -1
  s_branch L_fin
L_role_h1:
  s_waitcnt vmcnt(19)
  v_dot2c_f32_bf16_dpp v40, v36, v76 row_newbcast:0 row_mask:0xf bank_mask:0xf
  v_dot2c_f32_bf16_dpp v41, v38, v76 row_newbcast:0 row_mask:0xf bank_mask:0xf
  v_dot2c_f32_bf16_dpp v42, v36, v77 row_newbcast:0 row_mask:0xf bank_mask:0xf
  v_dot2c_f32_bf16_dpp v43, v38, v77 row_newbcast:0 row_mask:0xf bank_mask:0xf
  s_waitcnt vmcnt(18)
  v_dot2c_f32_bf16_dpp v40, v36, v78 row_newbcast:1 row_mask:0xf bank_mask:0xf
  v_dot2c_f32_bf16_dpp v41, v38, v78 row_newbcast:1 row_mask:0xf bank_mask:0xf
  v_dot2c_f32_bf16_dpp v42, v36, v79 row_newbcast:1 row_mask:0xf bank_mask:0xf
  v_dot2c_f32_bf16_dpp v43, v38, v79 row_newbcast:1 row_mask:0xf bank_mask:0xf
  s_waitcnt vmcnt(17)
  v_dot2c_f32_bf16_dpp v40, v36, v80 row_newbcast:2 row_mask:0xf bank_mask:0xf
  v_dot2c_f32_bf16_dpp v41, v38, v80 row_newbcast:2 row_mask:0xf bank_mask:0xf
  v_dot2c_f32_bf16_dpp v42, v36, v81 row_newbcast:2 row_mask:0xf bank_mask:0xf
  v_dot2c_f32_bf16_dpp v43, v38, v81 row_newbcast:2 row_mask:0xf bank_mask:0xf
  s_waitcnt vmcnt(16)
  v_dot2c_f32_bf16_dpp v40, v36, v82 row_newbcast:3 row_mask:0xf bank_mask:0xf
  v_dot2c_f32_bf16_dpp v41, v38, v82 row_newbcast:3 row_mask:0xf bank_mask:0xf
  v_dot2c_f32_bf16_dpp v42, v36, v83 row_newbcast:3 row_mask:0xf bank_mask:0xf
  v_dot2c_f32_bf16_dpp v43, v38, v83 row_newbcast:3 row_mask:0xf bank_mask:0xf
  s_waitcnt vmcnt(15)
  v_dot2c_f32_bf16_dpp v40, v36, v84 row_newbcast:4 row_mask:0xf bank_mask:0xf
  v_dot2c_f32_bf16_dpp v41, v38, v84 row_newbcast:4 row_mask:0xf bank_mask:0xf
  v_dot2c_f32_bf16_dpp v42, v36, v85 row_newbcast:4 row_mask:0xf bank_mask:0xf
  v_dot2c_f32_bf16_dpp v43, v38, v85 row_newbcast:4 row_mask:0xf bank_mask:0xf
  s_waitcnt vmcnt(14)
  v_dot2c_f32_bf16_dpp v40, v36, v86 row_newbcast:5 row_mask:0xf bank_mask:0xf
  v_dot2c_f32_bf16_dpp v41, v38, v86 row_newbcast:5 row_mask:0xf bank_mask:0xf
  v_dot2c_f32_bf16_dpp v42, v36, v87 row_newbcast:5 row_mask:0xf bank_mask:0xf
  v_dot2c_f32_bf16_dpp v43, v38, v87 row_newbcast:5 row_mask:0xf bank_mask:0xf
  s_waitcnt vmcnt(13)
  v_dot2c_f32_bf16_dpp v40, v36, v88 row_newbcast:6 row_mask:0xf bank_mask:0xf
  v_dot2c_f32_bf16_dpp v41, v38, v88 row_newbcast:6 row_mask:0xf bank_mask:0xf
  v_dot2c_f32_bf16_dpp v42, v36, v89 row_newbcast:6 row_mask:0xf bank_mask:0xf
  v_dot2c_f32_bf16_dpp v43, v38, v89 row_newbcast:6 row_mask:0xf bank_mask:0xf
  s_waitcnt vmcnt(12)
  v_dot2c_f32_bf16_dpp v40, v36, v90 row_newbcast:7 row_mask:0xf bank_mask:0xf
  v_dot2c_f32_bf16_dpp v41, v38, v90 row_newbcast:7 row_mask:0xf bank_mask:0xf
  v_dot2c_f32_bf16_dpp v42, v36, v91 row_newbcast:7 row_mask:0xf bank_mask:0xf
  v_dot2c_f32_bf16_dpp v43, v38, v91 row_newbcast:7 row_mask:0xf bank_mask:0xf
  s_waitcnt vmcnt(11)
  v_dot2c_f32_bf16_dpp v40, v36, v92 row_newbcast:8 row_mask:0xf bank_mask:0xf
  v_dot2c_f32_bf16_dpp v41, v38, v92 row_newbcast:8 row_mask:0xf bank_mask:0xf
  v_dot2c_f32_bf16_dpp v42, v36, v93 row_newbcast:8 row_mask:0xf bank_mask:0xf
  v_dot2c_f32_bf16_dpp v43, v38, v93 row_newbcast:8 row_mask:0xf bank_mask:0xf
  s_waitcnt vmcnt(10)
  v_dot2c_f32_bf16_dpp v40, v36, v94 row_newbcast:9 row_mask:0xf bank_mask:0xf
  v_dot2c_f32_bf16_dpp v41, v38, v94 row_newbcast:9 row_mask:0xf bank_mask:0xf
  v_dot2c_f32_bf16_dpp v42, v36, v95 row_newbcast:9 row_mask:0xf bank_mask:0xf
  v_dot2c_f32_bf16_dpp v43, v38, v95 row_newbcast:9 row_mask:0xf bank_mask:0xf
  s_waitcnt vmcnt(9)
  v_dot2c_f32_bf16_dpp v40, v36, v96 row_newbcast:10 row_mask:0xf bank_mask:0xf
  v_dot2c_f32_bf16_dpp v41, v38, v96 row_newbcast:10 row_mask:0xf bank_mask:0xf
  v_dot2c_f32_bf16_dpp v42, v36, v97 row_newbcast:10 row_mask:0xf bank_mask:0xf
  v_dot2c_f32_bf16_dpp v43, v38, v97 row_newbcast:10 row_mask:0xf bank_mask:0xf
  s_waitcnt vmcnt(8)
  v_dot2c_f32_bf16_dpp v40, v36, v98 row_newbcast:11 row_mask:0xf bank_mask:0xf
  v_dot2c_f32_bf16_dpp v41, v38, v98 row_newbcast:11 row_mask:0xf bank_mask:0xf
  v_dot2c_f32_bf16_dpp v42, v36, v99 row_newbcast:11 row_mask:0xf bank_mask:0xf
  v_dot2c_f32_bf16_dpp v43, v38, v99 row_newbcast:11 row_mask:0xf bank_mask:0xf
  s_waitcnt vmcnt(7)
  v_dot2c_f32_bf16_dpp v40, v36, v100 row_newbcast:12 row_mask:0xf bank_mask:0xf
  v_dot2c_f32_bf16_dpp v41, v38, v100 row_newbcast:12 row_mask:0xf bank_mask:0xf
  v_dot2c_f32_bf16_dpp v42, v36, v101 row_newbcast:12 row_mask:0xf bank_mask:0xf
  v_dot2c_f32_bf16_dpp v43, v38, v101 row_newbcast:12 row_mask:0xf bank_mask:0xf
  s_waitcnt vmcnt(6)
  v_dot2c_f32_bf16_dpp v40, v36, v102 row_newbcast:13 row_mask:0xf bank_mask:0xf
  v_dot2c_f32_bf16_dpp v41, v38, v102 row_newbcast:13 row_mask:0xf bank_mask:0xf
  v_dot2c_f32_bf16_dpp v42, v36, v103 row_newbcast:13 row_mask:0xf bank_mask:0xf
  v_dot2c_f32_bf16_dpp v43, v38, v103 row_newbcast:13 row_mask:0xf bank_mask:0xf
  s_waitcnt vmcnt(5)
  v_dot2c_f32_bf16_dpp v40, v36, v104 row_newbcast:14 row_mask:0xf bank_mask:0xf
  v_dot2c_f32_bf16_dpp v41, v38, v104 row_newbcast:14 row_mask:0xf bank_mask:0xf
  v_dot2c_f32_bf16_dpp v42, v36, v105 row_newbcast:14 row_mask:0xf bank_mask:0xf
  v_dot2c_f32_bf16_dpp v43, v38, v105 row_newbcast:14 row_mask:0xf bank_mask:0xf
  s_waitcnt vmcnt(4)
  v_dot2c_f32_bf16_dpp v40, v36, v106 row_newbcast:15 row_mask:0xf bank_mask:0xf
  v_dot2c_f32_bf16_dpp v41, v38, v106 row_newbcast:15 row_mask:0xf bank_mask:0xf
  v_dot2c_f32_bf16_dpp v42, v36, v107 row_newbcast:15 row_mask:0xf bank_mask:0xf
  v_dot2c_f32_bf16_dpp v43, v38, v107 row_newbcast:15 row_mask:0xf bank_mask:0xf
  s_waitcnt vmcnt(3)
  v_dot2c_f32_bf16_dpp v40, v37, v108 row_newbcast:0 row_mask:0xf bank_mask:0xf
  v_dot2c_f32_bf16_dpp v41, v39, v108 row_newbcast:0 row_mask:0xf bank_mask:0xf
  v_dot2c_f32_bf16_dpp v42, v37, v109 row_newbcast:0 row_mask:0xf bank_mask:0xf
  v_dot2c_f32_bf16_dpp v43, v39, v109 row_newbcast:0 row_mask:0xf bank_mask:0xf
  s_waitcnt vmcnt(2)
  v_dot2c_f32_bf16_dpp v40, v37, v110 row_newbcast:1 row_mask:0xf bank_mask:0xf
  v_dot2c_f32_bf16_dpp v41, v39, v110 row_newbcast:1 row_mask:0xf bank_mask:0xf
  v_dot2c_f32_bf16_dpp v42, v37, v111 row_newbcast:1 row_mask:0xf bank_mask:0xf
  v_dot2c_f32_bf16_dpp v43, v39, v111 row_newbcast:1 row_mask:0xf bank_mask:0xf
  s_waitcnt vmcnt(1)
  v_dot2c_f32_bf16_dpp v40, v37, v112 row_newbcast:2 row_mask:0xf bank_mask:0xf
  v_dot2c_f32_bf16_dpp v41, v39, v112 row_newbcast:2 row_mask:0xf bank_mask:0xf
  v_dot2c_f32_bf16_dpp v42, v37, v113 row_newbcast:2 row_mask:0xf bank_mask:0xf
  v_dot2c_f32_bf16_dpp v43, v39, v113 row_newbcast:2 row_mask:0xf bank_mask:0xf
  s_waitcnt vmcnt(0)
  v_dot2c_f32_bf16_dpp v40, v37, v114 row_newbcast:3 row_mask:0xf bank_mask:0xf
  v_dot2c_f32_bf16_dpp v41, v39, v114 row_newbcast:3 row_mask:0xf bank_mask:0xf
  v_dot2c_f32_bf16_dpp v42, v37, v115 row_newbcast:3 row_mask:0xf bank_mask:0xf
  v_dot2c_f32_bf16_dpp v43, v39, v115 row_newbcast:3 row_mask:0xf bank_mask:0xf
  s_nop 2
  v_permlane32_swap_b32 v40, v42
  v_add_f32 v40, v40, v42
  v_permlane32_swap_b32 v41, v43
  v_add_f32 v41, v41, v43
  s_nop 1
  v_permlane16_swap_b32 v40, v41
  v_add_f32 v24, v40, v41
  s_cmp_eq_u32 s35, 0
  s_cbranch_scc1 L_h_nopub
  buffer_store_dwordx2 v[24:25], v19, s[84:87], s30 offen sc1
L_h_nopub:
  s_setprio 0
  s_barrier
  v_lshrrev_b32 v24, 4, v1
  v_and_b32 v25, 15, v1
  v_lshrrev_b32 v26, 3, v1
  v_and_b32 v27, 7, v1
  v_mul_u32_u24 v4, 1280, v26
  v_lshl_add_u32 v4, v27, 4, v4
  v_lshrrev_b32 v28, 1, v1
  v_mul_u32_u24 v5, 1280, v28
  v_and_b32 v17, 1, v1
  v_lshl_add_u32 v5, v17, 4, v5
  v_add_u32 v5, 128, v5
  v_lshrrev_b32 v8, 5, v1
  v_lshlrev_b32 v8, 9, v8
  v_and_b32 v20, 31, v1
  v_lshl_add_u32 v8, v20, 4, v8
  v_lshlrev_b32 v20, 2, v20
  v_lshrrev_b32 v16, 1, v26
  v_lshlrev_b32 v16, 2, v16
  v_and_b32 v9, 1, v26
  v_lshlrev_b32 v9, 4, v9
  v_lshrrev_b32 v21, 1, v28
  v_lshlrev_b32 v21, 2, v21
  v_and_b32 v12, 1, v28
  v_lshlrev_b32 v12, 4, v12
  s_mul_i32 s8, s4, 160
  s_lshl_b32 s7, s3, 6
  s_mul_i32 s17, s7, 1280
  s_add_u32 s17, s17, s8
  s_add_u32 s17, s17, s39
  s_lshl_b32 s7, s3, 12
  s_add_u32 s27, s7, 266240
  s_lshl_b32 s7, s3, 13
  s_add_u32 s7, s7, 4096
  s_cmp_eq_u32 s35, 0
  s_cselect_b32 s27, s7, s27
  s_lshl_b32 s7, s3, 10
  s_add_u32 s33, s7, 659456
  s_lshl_b32 s8, s4, 7
  s_add_u32 s33, s33, s8
  s_mul_i32 s8, s4, 20480
  s_lshl_b32 s7, s3, 7
  s_add_u32 s34, s8, s7
  s_add_u32 s34, s34, 856064
  s_barrier
  s_barrier
  s_barrier
  s_lshl_b32 s7, s3, 7
  buffer_load_dword v22, v20, s[68:71], s7 offen
  buffer_load_dwordx4 v[116:119], v8, s[84:87], s27 offen offset:0 sc1
  buffer_load_dwordx4 v[120:123], v8, s[84:87], s27 offen offset:1024 sc1
  buffer_load_dwordx4 v[124:127], v8, s[84:87], s27 offen offset:2048 sc1
  buffer_load_dwordx4 v[128:131], v8, s[84:87], s27 offen offset:3072 sc1
L_sp3:
  ds_read_b32 v28, v18 offset:6152
  s_waitcnt lgkmcnt(0)
  v_readfirstlane_b32 s7, v28
  s_nop 0
  s_cmp_ge_u32 s7, 8
  s_cbranch_scc1 L_sp3_ok
  s_sleep 1
  s_branch L_sp3
L_sp3_ok:
  s_setprio 3
  v_lshlrev_b32 v20, 3, v1
  ds_read_b64 v[40:41], v20 offset:4352
  ds_read_b32 v24, v18 offset:6168
  v_mov_b32 v25, s6
  v_mov_b32 v27, s6
  s_waitcnt lgkmcnt(0)
  v_add_f32 v26, v40, v41
  s_nop 1
  v_add_f32_dpp v26, v26, v26 row_ror:8 row_mask:0xf bank_mask:0xf
  s_nop 1
  v_add_f32_dpp v26, v26, v26 row_ror:4 row_mask:0xf bank_mask:0xf
  s_nop 1
  v_add_f32_dpp v26, v26, v26 row_ror:2 row_mask:0xf bank_mask:0xf
  s_nop 1
  v_add_f32_dpp v26, v26, v26 row_ror:1 row_mask:0xf bank_mask:0xf
  v_mov_b32 v28, v26
  s_nop 1
  v_permlane16_swap_b32 v26, v28
  v_add_f32 v26, v26, v28
  v_mov_b32 v28, v26
  s_nop 1
  v_permlane32_swap_b32 v26, v28
  v_add_f32 v26, v26, v28
  s_mov_b64 exec, 0xff
  buffer_store_dwordx4 v[24:27], v2, s[84:87], s33 offen sc1
  s_mov_b64 exec, -1
  s_mov_b64 exec, 1
  ds_add_u32 v18, v30 offset:6164
  s_mov_b64 exec, -1
  s_setprio 0
  s_cmp_eq_u32 s35, 0
  s_cbranch_scc1 L_fin
  buffer_load_dwordx4 v[76:79], v4, s[72:75], s17 offen nt
  s_add_u32 s17, s17, 10240
  buffer_load_dwordx4 v[80:83], v4, s[72:75], s17 offen nt
  s_add_u32 s17, s17, 10240
  buffer_load_dwordx4 v[84:87], v4, s[72:75], s17 offen nt
  s_add_u32 s17, s17, 10240
  buffer_load_dwordx4 v[88:91], v4, s[72:75], s17 offen nt
  s_add_u32 s17, s17, 10240
  buffer_load_dwordx4 v[92:95], v4, s[72:75], s17 offen nt
  s_add_u32 s17, s17, 10240
  buffer_load_dwordx4 v[96:99], v4, s[72:75], s17 offen nt
  s_add_u32 s17, s17, 10240
  buffer_load_dwordx4 v[100:103], v4, s[72:75], s17 offen nt
  s_add_u32 s17, s17, 10240
  buffer_load_dwordx4 v[104:107], v4, s[72:75], s17 offen nt
  s_add_u32 s17, s17, 10240
  s_sub_u32 s17, s17, 81920
  buffer_load_dwordx4 v[108:111], v5, s[72:75], s17 offen nt
  s_add_u32 s17, s17, 40960
  buffer_load_dwordx4 v[112:115], v5, s[72:75], s17 offen nt
  s_waitcnt vmcnt(10)
  v_min3_u32 v24, v117, v119, v121
  v_min3_u32 v24, v24, v123, v125
  v_min3_u32 v24, v24, v127, v129
  v_min_u32 v24, v24, v131
  v_max3_u32 v25, v117, v119, v121
  v_max3_u32 v25, v25, v123, v125
  v_max3_u32 v25, v25, v127, v129
  v_max_u32 v25, v25, v131
  v_cmp_ne_u32 vcc, s6, v24
  v_cmp_ne_u32 s[12:13], s6, v25
  s_or_b64 vcc, vcc, s[12:13]
  s_cbranch_vccz L_hok
L_hretry:
  s_add_u32 s11, s11, 16
  s_and_b32 s7, s11, 0xfff0
  s_cmp_gt_u32 s7, 0xff00
  s_cbranch_scc1 L_hok
  buffer_load_dwordx4 v[116:119], v8, s[84:87], s27 offen offset:0 sc1
  buffer_load_dwordx4 v[120:123], v8, s[84:87], s27 offen offset:1024 sc1
  buffer_load_dwordx4 v[124:127], v8, s[84:87], s27 offen offset:2048 sc1
  buffer_load_dwordx4 v[128:131], v8, s[84:87], s27 offen offset:3072 sc1
  s_waitcnt vmcnt(0)
  v_min3_u32 v24, v117, v119, v121
  v_min3_u32 v24, v24, v123, v125
  v_min3_u32 v24, v24, v127, v129
  v_min_u32 v24, v24, v131
  v_max3_u32 v25, v117, v119, v121
  v_max3_u32 v25, v25, v123, v125
  v_max3_u32 v25, v25, v127, v129
  v_max_u32 v25, v25, v131
  v_cmp_ne_u32 vcc, s6, v24
  v_cmp_ne_u32 s[12:13], s6, v25
  s_or_b64 vcc, vcc, s[12:13]
  s_cbranch_vccnz L_hretry
L_hok:
  v_add_f32 v116, v116, v120
  v_add_f32 v118, v118, v122
  v_add_f32 v124, v124, v128
  v_add_f32 v126, v126, v130
  v_add_f32 v116, v116, v124
  v_add_f32 v118, v118, v126
  v_mov_b32 v24, v116
  v_mov_b32 v25, v118
  s_nop 1
  v_permlane32_swap_b32 v116, v24
  v_permlane32_swap_b32 v118, v25
  v_add_f32 v116, v116, v24
  v_add_f32 v118, v118, v25
  v_cvt_pk_bf16_f32 v24, v116, v118
  v_lshlrev_b32 v116, 16, v24
  v_and_b32 v118, 0xffff0000, v24
  v_lshlrev_b32 v24, 16, v22
  v_and_b32 v25, 0xffff0000, v22
  v_add_f32 v116, v116, v24
  v_add_f32 v118, v118, v25
  v_cvt_pk_bf16_f32 v24, v116, v118
  v_lshlrev_b32 v116, 16, v24
  v_and_b32 v118, 0xffff0000, v24
  s_mov_b32 s7, 0x3d372713
  s_mov_b32 s8, 0xc0135761
  v_mul_f32 v24, v116, v116
  v_mul_f32 v24, s7, v24
  v_fma_f32 v24, v24, v116, v116
  v_mul_f32 v24, s8, v24
  v_exp_f32 v24, v24
  s_nop 0
  v_add_f32 v24, 1.0, v24
  v_rcp_f32 v24, v24
  s_nop 0
  v_mul_f32 v116, v116, v24
  v_mul_f32 v25, v118, v118
  v_mul_f32 v25, s7, v25
  v_fma_f32 v25, v25, v118, v118
  v_mul_f32 v25, s8, v25
  v_exp_f32 v25, v25
  s_nop 0
  v_add_f32 v25, 1.0, v25
  v_rcp_f32 v25, v25
  s_nop 0
  v_mul_f32 v118, v118, v25
  v_cvt_pk_bf16_f32 v137, v116, v118
  ds_bpermute_b32 v56, v16, v137 offset:0
  ds_bpermute_b32 v57, v16, v137 offset:16
  ds_bpermute_b32 v58, v16, v137 offset:32
  ds_bpermute_b32 v59, v16, v137 offset:48
  ds_bpermute_b32 v60, v16, v137 offset:64
  ds_bpermute_b32 v61, v16, v137 offset:80
  ds_bpermute_b32 v62, v16, v137 offset:96
  ds_bpermute_b32 v63, v16, v137 offset:112
  ds_bpermute_b32 v64, v21, v137 offset:0
  ds_bpermute_b32 v65, v21, v137 offset:64
  v_mov_b32 v40, 0
  v_mov_b32 v41, 0
  v_mov_b32 v42, 0
  v_mov_b32 v43, 0
  v_mov_b32 v44, 0
  v_mov_b32 v45, 0
  v_mov_b32 v46, 0
  v_mov_b32 v47, 0
  v_mov_b32 v48, 0
  v_mov_b32 v49, 0
  v_mov_b32 v50, 0
  v_mov_b32 v51, 0
  v_mov_b32 v52, 0
  v_mov_b32 v53, 0
  v_mov_b32 v54, 0
  v_mov_b32 v55, 0
  s_waitcnt lgkmcnt(0)
  v_lshrrev_b32 v56, v9, v56
  v_lshlrev_b32 v66, 16, v56
  v_and_b32 v56, 0xffff, v56
  v_lshrrev_b32 v57, v9, v57
  v_lshlrev_b32 v67, 16, v57
  v_and_b32 v57, 0xffff, v57
  v_lshrrev_b32 v58, v9, v58
  v_lshlrev_b32 v68, 16, v58
  v_and_b32 v58, 0xffff, v58
  v_lshrrev_b32 v59, v9, v59
  v_lshlrev_b32 v69, 16, v59
  v_and_b32 v59, 0xffff, v59
  v_lshrrev_b32 v60, v9, v60
  v_lshlrev_b32 v70, 16, v60
  v_and_b32 v60, 0xffff, v60
  v_lshrrev_b32 v61, v9, v61
  v_lshlrev_b32 v71, 16, v61
  v_and_b32 v61, 0xffff, v61
  v_lshrrev_b32 v62, v9, v62
  v_lshlrev_b32 v72, 16, v62
  v_and_b32 v62, 0xffff, v62
  v_lshrrev_b32 v63, v9, v63
  v_lshlrev_b32 v73, 16, v63
  v_and_b32 v63, 0xffff, v63
  v_lshrrev_b32 v64, v12, v64
  v_lshlrev_b32 v74, 16, v64
  v_and_b32 v64, 0xffff, v64
  v_lshrrev_b32 v65, v12, v65
  v_lshlrev_b32 v75, 16, v65
  v_and_b32 v65, 0xffff, v65
  s_waitcnt vmcnt(0)
  v_dot2c_f32_bf16 v40, v76, v56
  v_dot2c_f32_bf16 v41, v76, v66
  v_dot2c_f32_bf16 v42, v77, v56
  v_dot2c_f32_bf16 v43, v77, v66
  v_dot2c_f32_bf16 v44, v78, v56
  v_dot2c_f32_bf16 v45, v78, v66
  v_dot2c_f32_bf16 v46, v79, v56
  v_dot2c_f32_bf16 v47, v79, v66
  v_dot2c_f32_bf16 v40, v80, v57
  v_dot2c_f32_bf16 v41, v80, v67
  v_dot2c_f32_bf16 v42, v81, v57
  v_dot2c_f32_bf16 v43, v81, v67
  v_dot2c_f32_bf16 v44, v82, v57
  v_dot2c_f32_bf16 v45, v82, v67
  v_dot2c_f32_bf16 v46, v83, v57
  v_dot2c_f32_bf16 v47, v83, v67
  v_dot2c_f32_bf16 v40, v84, v58
  v_dot2c_f32_bf16 v41, v84, v68
  v_dot2c_f32_bf16 v42, v85, v58
  v_dot2c_f32_bf16 v43, v85, v68
  v_dot2c_f32_bf16 v44, v86, v58
  v_dot2c_f32_bf16 v45, v86, v68
  v_dot2c_f32_bf16 v46, v87, v58
  v_dot2c_f32_bf16 v47, v87, v68
  v_dot2c_f32_bf16 v40, v88, v59
  v_dot2c_f32_bf16 v41, v88, v69
  v_dot2c_f32_bf16 v42, v89, v59
  v_dot2c_f32_bf16 v43, v89, v69
  v_dot2c_f32_bf16 v44, v90, v59
  v_dot2c_f32_bf16 v45, v90, v69
  v_dot2c_f32_bf16 v46, v91, v59
  v_dot2c_f32_bf16 v47, v91, v69
  v_dot2c_f32_bf16 v40, v92, v60
  v_dot2c_f32_bf16 v41, v92, v70
  v_dot2c_f32_bf16 v42, v93, v60
  v_dot2c_f32_bf16 v43, v93, v70
  v_dot2c_f32_bf16 v44, v94, v60
  v_dot2c_f32_bf16 v45, v94, v70
  v_dot2c_f32_bf16 v46, v95, v60
  v_dot2c_f32_bf16 v47, v95, v70
  v_dot2c_f32_bf16 v40, v96, v61
  v_dot2c_f32_bf16 v41, v96, v71
  v_dot2c_f32_bf16 v42, v97, v61
  v_dot2c_f32_bf16 v43, v97, v71
  v_dot2c_f32_bf16 v44, v98, v61
  v_dot2c_f32_bf16 v45, v98, v71
  v_dot2c_f32_bf16 v46, v99, v61
  v_dot2c_f32_bf16 v47, v99, v71
  v_dot2c_f32_bf16 v40, v100, v62
  v_dot2c_f32_bf16 v41, v100, v72
  v_dot2c_f32_bf16 v42, v101, v62
  v_dot2c_f32_bf16 v43, v101, v72
  v_dot2c_f32_bf16 v44, v102, v62
  v_dot2c_f32_bf16 v45, v102, v72
  v_dot2c_f32_bf16 v46, v103, v62
  v_dot2c_f32_bf16 v47, v103, v72
  v_dot2c_f32_bf16 v40, v104, v63
  v_dot2c_f32_bf16 v41, v104, v73
  v_dot2c_f32_bf16 v42, v105, v63
  v_dot2c_f32_bf16 v43, v105, v73
  v_dot2c_f32_bf16 v44, v106, v63
  v_dot2c_f32_bf16 v45, v106, v73
  v_dot2c_f32_bf16 v46, v107, v63
  v_dot2c_f32_bf16 v47, v107, v73
  v_dot2c_f32_bf16 v48, v108, v64
  v_dot2c_f32_bf16 v49, v108, v74
  v_dot2c_f32_bf16 v50, v109, v64
  v_dot2c_f32_bf16 v51, v109, v74
  v_dot2c_f32_bf16 v52, v110, v64
  v_dot2c_f32_bf16 v53, v110, v74
  v_dot2c_f32_bf16 v54, v111, v64
  v_dot2c_f32_bf16 v55, v111, v74
  v_dot2c_f32_bf16 v48, v112, v65
  v_dot2c_f32_bf16 v49, v112, v75
  v_dot2c_f32_bf16 v50, v113, v65
  v_dot2c_f32_bf16 v51, v113, v75
  v_dot2c_f32_bf16 v52, v114, v65
  v_dot2c_f32_bf16 v53, v114, v75
  v_dot2c_f32_bf16 v54, v115, v65
  v_dot2c_f32_bf16 v55, v115, v75
  s_nop 2
  v_permlane32_swap_b32 v40, v44
  v_add_f32 v40, v40, v44
  v_permlane32_swap_b32 v42, v46
  v_add_f32 v42, v42, v46
  v_permlane32_swap_b32 v41, v45
  v_add_f32 v41, v41, v45
  v_permlane32_swap_b32 v43, v47
  v_add_f32 v43, v43, v47
  v_permlane32_swap_b32 v48, v52
  v_add_f32 v48, v48, v52
  v_permlane32_swap_b32 v50, v54
  v_add_f32 v50, v50, v54
  v_permlane32_swap_b32 v49, v53
  v_add_f32 v49, v49, v53
  v_permlane32_swap_b32 v51, v55
  v_add_f32 v51, v51, v55
  s_nop 0
  v_permlane16_swap_b32 v40, v42
  v_add_f32 v40, v40, v42
  v_permlane16_swap_b32 v41, v43
  v_add_f32 v41, v41, v43
  v_permlane16_swap_b32 v48, v50
  v_add_f32 v48, v48, v50
  v_permlane16_swap_b32 v49, v51
  v_add_f32 v49, v49, v51
  s_nop 1
  v_add_f32_dpp v40, v40, v40 row_ror:8 row_mask:0xf bank_mask:0xf
  v_add_f32_dpp v41, v41, v41 row_ror:8 row_mask:0xf bank_mask:0xf
  v_add_f32_dpp v48, v48, v48 row_ror:8 row_mask:0xf bank_mask:0xf
  v_add_f32_dpp v49, v49, v49 row_ror:8 row_mask:0xf bank_mask:0xf
  s_nop 0
  v_add_f32_dpp v48, v48, v48 row_ror:4 row_mask:0xf bank_mask:0xf
  v_add_f32_dpp v49, v49, v49 row_ror:4 row_mask:0xf bank_mask:0xf
  s_nop 1
  v_add_f32_dpp v48, v48, v48 quad_perm:[2,3,0,1] row_mask:0xf bank_mask:0xf
  v_add_f32_dpp v49, v49, v49 quad_perm:[2,3,0,1] row_mask:0xf bank_mask:0xf
  v_lshrrev_b32 v24, 4, v1
  v_and_b32 v27, 7, v1
  v_lshl_add_u32 v25, v27, 2, v24
  v_lshrrev_b32 v26, 3, v25
  v_and_b32 v25, 7, v25
  v_lshlrev_b32 v25, 4, v25
  v_lshl_add_u32 v15, v26, 12, v25
  v_and_b32 v27, 1, v1
  v_lshl_add_u32 v25, v27, 2, v24
  v_lshlrev_b32 v11, 4, v25
  v_add_u32 v11, 16384, v11
  v_mov_b32 v43, s6
  v_mov_b32 v42, v41
  v_mov_b32 v41, s6
  v_mov_b32 v51, s6
  v_mov_b32 v50, v49
  v_mov_b32 v49, s6
  s_mov_b32 exec_lo, 0x00ff00ff
  s_mov_b32 exec_hi, 0x00ff00ff
  buffer_store_dwordx4 v[40:43], v15, s[84:87], s34 offen sc1
  s_mov_b32 exec_lo, 0x00030003
  s_mov_b32 exec_hi, 0x00030003
  buffer_store_dwordx4 v[48:51], v11, s[84:87], s34 offen sc1
  s_mov_b64 exec, -1
  s_branch L_fin
L_notfront:
  v_mov_b32 v30, 1
  s_mov_b32 s11, 0
  s_mov_b32 s37, 0x3fb8aa3b
  s_cmp_ge_u32 s5, 4
  s_cbranch_scc1 L_kv
L_t:
  s_load_dwordx2 s[60:61], s[0:1], 32
  s_load_dwordx2 s[76:77], s[0:1], 72
  s_load_dwordx2 s[80:81], s[0:1], 80
  s_mov_b32 s46, 1280
  s_mov_b32 s47, 0x20000
  s_mov_b32 s86, 1544192
  s_mov_b32 s87, 0x20000
  s_mov_b32 s62, 5242880
  s_mov_b32 s63, 0x20000
  s_mov_b32 s78, 1280
  s_mov_b32 s79, 0x20000
  s_mov_b32 s82, 1280
  s_mov_b32 s83, 0x20000
  v_lshrrev_b32 v26, 3, v1
  v_and_b32 v27, 7, v1
  s_sub_u32 s14, s5, 2
  v_mov_b32 v28, 0
  v_lshlrev_b32 v10, 2, v1
  ds_write_b32 v10, v28 offset:6144
  v_mov_b32 v28, 0xff800000
  ds_write_b32 v18, v28 offset:6168
  v_mul_u32_u24 v4, 1280, v26
  v_lshl_add_u32 v4, v27, 4, v4
  v_lshrrev_b32 v28, 1, v1
  v_mul_u32_u24 v5, 1280, v28
  v_and_b32 v17, 1, v1
  v_lshl_add_u32 v5, v17, 4, v5
  v_add_u32 v5, 128, v5
  v_lshrrev_b32 v8, 5, v1
  v_lshlrev_b32 v8, 10, v8
  v_and_b32 v20, 31, v1
  v_lshl_add_u32 v8, v20, 4, v8
  v_lshlrev_b32 v9, 7, v27
  v_lshrrev_b32 v16, 1, v26
  v_lshlrev_b32 v16, 2, v16
  v_and_b32 v19, 1, v26
  v_lshlrev_b32 v19, 4, v19
  v_lshrrev_b32 v21, 1, v28
  v_lshlrev_b32 v21, 2, v21
  v_and_b32 v12, 1, v28
  v_lshlrev_b32 v12, 4, v12
  s_mul_i32 s7, s14, 640
  v_and_b32 v13, 1, v24
  v_lshlrev_b32 v13, 5, v13
  v_add_lshl_u32 v13, v13, v27, 2
  v_lshrrev_b32 v14, 1, v24
  v_mul_u32_u24 v14, 320, v14
  v_add3_u32 v13, v13, v14, s7
  v_add_u32 v13, 4864, v13
  v_lshlrev_b32 v14, 5, v17
  v_lshl_add_u32 v14, v24, 3, v14
  v_add_u32 v14, s7, v14
  v_add_u32 v14, 256, v14
  v_mov_b32 v40, 0
  v_mov_b32 v41, 0
  ds_write_b64 v14, v[40:41] offset:5184
  v_and_b32 v140, 1, v27
  v_mov_b32 v141, 0xffff
  v_mov_b32 v142, 0xffff0000
  v_cmp_eq_u32 vcc, 0, v140
  v_lshrrev_b32 v42, 1, v27
  s_nop 0
  v_cndmask_b32 v43, v142, v141, vcc
  v_cmp_eq_u32 vcc, 0, v42
  v_cmp_eq_u32 s[12:13], 1, v42
  s_nop 0
  v_cndmask_b32 v140, 0, v43, vcc
  v_cndmask_b32 v141, 0, v43, s[12:13]
  v_cmp_eq_u32 vcc, 2, v42
  v_cmp_eq_u32 s[12:13], 3, v42
  s_nop 0
  v_cndmask_b32 v142, 0, v43, vcc
  v_cndmask_b32 v143, 0, v43, s[12:13]
  v_and_b32 v7, 28, v10
  v_mov_b32 v15, 0x0c0c0100
  v_mov_b32 v11, 0x0c0c0302
  v_cmp_eq_u32 vcc, 0, v19
  v_cmp_eq_u32 s[12:13], 0, v12
  s_nop 1
  v_cndmask_b32 v12, v11, v15, s[12:13]
  v_mov_b32 v15, 0x01000c0c
  v_mov_b32 v11, 0x03020c0c
  v_cndmask_b32 v6, v11, v15, s[12:13]
  v_mov_b32 v15, 0x01000100
  v_mov_b32 v11, 0x03020302
  v_cndmask_b32 v3, v11, v15, vcc
  s_add_u32 s16, s3, 5
  s_and_b32 s16, s16, 31
  s_lshl_b32 s7, s16, 7
  s_lshl_b32 s8, s14, 6
  s_add_u32 s7, s7, s8
  s_mul_i32 s17, s7, 1280
  s_mul_i32 s9, s4, 160
  s_add_u32 s17, s17, s9
  s_lshl_b32 s8, s14, 9
  s_lshl_b32 s10, s16, 13
  s_add_u32 s8, s8, s10
  s_add_u32 s28, s8, 397312
  s_add_u32 s32, s28, 4096
  s_lshl_b32 s7, s16, 10
  s_add_u32 s29, s7, 659456
  s_sub_u32 s7, s3, 27
  s_lshl_b32 s7, s7, 3
  s_add_u32 s7, s7, s4
  s_lshl_b32 s38, s7, 5
  s_lshl_b32 s7, s7, 12
  s_add_u32 s15, s7, 856064
  s_add_u32 s24, s7, 692224
  s_waitcnt lgkmcnt(0)
  s_barrier
  buffer_load_dword v29, v18, s[84:87], 0 offen sc1
  s_barrier
  s_waitcnt vmcnt(0)
  v_readfirstlane_b32 s6, v29
  s_nop 0
  s_add_u32 s6, s6, 2654435769
  s_barrier
  s_barrier
  s_barrier
  buffer_load_dwordx4 v[76:79], v4, s[60:63], s17 offen nt
  s_add_u32 s17, s17, 10240
  buffer_load_dwordx4 v[80:83], v4, s[60:63], s17 offen nt
  s_add_u32 s17, s17, 10240
  buffer_load_dwordx4 v[84:87], v4, s[60:63], s17 offen nt
  s_add_u32 s17, s17, 10240
  buffer_load_dwordx4 v[88:91], v4, s[60:63], s17 offen nt
  s_add_u32 s17, s17, 10240
  buffer_load_dwordx4 v[92:95], v4, s[60:63], s17 offen nt
  s_add_u32 s17, s17, 10240
  buffer_load_dwordx4 v[96:99], v4, s[60:63], s17 offen nt
  s_add_u32 s17, s17, 10240
  buffer_load_dwordx4 v[100:103], v4, s[60:63], s17 offen nt
  s_add_u32 s17, s17, 10240
  buffer_load_dwordx4 v[104:107], v4, s[60:63], s17 offen nt
  s_add_u32 s17, s17, 10240
  s_sub_u32 s17, s17, 81920
  buffer_load_dwordx4 v[108:111], v5, s[60:63], s17 offen nt
  s_add_u32 s17, s17, 40960
  buffer_load_dwordx4 v[112:115], v5, s[60:63], s17 offen nt
  buffer_load_dword v23, v7, s[44:47], s38 offen
  buffer_load_dword v136, v7, s[76:79], s38 offen
  v_mov_b32 v40, 0
  v_mov_b32 v41, 0
  v_mov_b32 v42, 0
  v_mov_b32 v43, 0
  v_mov_b32 v44, 0
  v_mov_b32 v45, 0
  v_mov_b32 v46, 0
  v_mov_b32 v47, 0
  v_mov_b32 v48, 0
  v_mov_b32 v49, 0
  v_mov_b32 v50, 0
  v_mov_b32 v51, 0
  v_mov_b32 v52, 0
  v_mov_b32 v53, 0
  v_mov_b32 v54, 0
  v_mov_b32 v55, 0
  s_waitcnt vmcnt(0)
L_sp4:
  ds_read_b32 v28, v18 offset:6164
  s_waitcnt lgkmcnt(0)
  v_readfirstlane_b32 s7, v28
  s_nop 0
  s_cmp_ge_u32 s7, 2
  s_cbranch_scc1 L_sp4_ok
  s_sleep 1
  s_branch L_sp4
L_sp4_ok:
L_oretry:
  buffer_load_dwordx4 v[116:119], v8, s[84:87], s28 offen offset:0 sc1
  buffer_load_dwordx4 v[120:123], v8, s[84:87], s28 offen offset:2048 sc1
  buffer_load_dwordx4 v[124:127], v8, s[84:87], s32 offen offset:0 sc1
  buffer_load_dwordx4 v[128:131], v8, s[84:87], s32 offen offset:2048 sc1
  buffer_load_dwordx4 v[132:135], v9, s[84:87], s29 offen sc1
  s_add_u32 s11, s11, 65536
  s_waitcnt vmcnt(0)
  v_min3_u32 v24, v117, v119, v121
  v_min3_u32 v24, v24, v123, v125
  v_min3_u32 v24, v24, v127, v129
  v_min3_u32 v24, v24, v131, v133
  v_min_u32 v24, v24, v135
  v_max3_u32 v25, v117, v119, v121
  v_max3_u32 v25, v25, v123, v125
  v_max3_u32 v25, v25, v127, v129
  v_max3_u32 v25, v25, v131, v133
  v_max_u32 v25, v25, v135
  v_cmp_ne_u32 vcc, s6, v24
  v_cmp_ne_u32 s[12:13], s6, v25
  s_or_b64 vcc, vcc, s[12:13]
  s_cmp_gt_u32 s11, 0x7f000000
  s_cbranch_scc1 L_ook
  s_cbranch_vccnz L_oretry
L_ook:
  s_setprio 3
  v_mov_b32 v24, v132
  s_nop 1
  v_max_f32_dpp v24, v24, v24 row_ror:4 row_mask:0xf bank_mask:0xf
  s_nop 1
  v_max_f32_dpp v24, v24, v24 row_ror:2 row_mask:0xf bank_mask:0xf
  s_nop 1
  v_max_f32_dpp v24, v24, v24 row_ror:1 row_mask:0xf bank_mask:0xf
  v_sub_f32 v25, v132, v24
  v_mul_f32 v25, s37, v25
  v_exp_f32 v25, v25
  s_nop 0
  v_mul_f32 v26, v25, v134
  v_mov_b32_dpp v56, v25 row_newbcast:0 row_mask:0x3 bank_mask:0xf
  v_mov_b32_dpp v56, v25 row_newbcast:1 row_mask:0xc bank_mask:0xf
  v_add_f32_dpp v26, v26, v26 row_ror:4 row_mask:0xf bank_mask:0xf
  v_mov_b32_dpp v57, v25 row_newbcast:2 row_mask:0x3 bank_mask:0xf
  v_mov_b32_dpp v57, v25 row_newbcast:3 row_mask:0xc bank_mask:0xf
  v_add_f32_dpp v26, v26, v26 row_ror:2 row_mask:0xf bank_mask:0xf
  v_mov_b32_dpp v58, v25 row_newbcast:4 row_mask:0x3 bank_mask:0xf
  v_mov_b32_dpp v58, v25 row_newbcast:5 row_mask:0xc bank_mask:0xf
  v_add_f32_dpp v26, v26, v26 row_ror:1 row_mask:0xf bank_mask:0xf
  v_mov_b32_dpp v59, v25 row_newbcast:6 row_mask:0x3 bank_mask:0xf
  v_mov_b32_dpp v59, v25 row_newbcast:7 row_mask:0xc bank_mask:0xf
  v_mul_f32 v27, v116, v56
  v_mul_f32 v28, v118, v56
  v_fmac_f32 v27, v120, v57
  v_fmac_f32 v28, v122, v57
  v_fmac_f32 v27, v124, v58
  v_fmac_f32 v28, v126, v58
  v_fmac_f32 v27, v128, v59
  v_fmac_f32 v28, v130, v59
  v_rcp_f32 v26, v26
  v_mov_b32 v24, v27
  v_mov_b32 v25, v28
  s_nop 1
  v_permlane32_swap_b32 v27, v24
  v_permlane32_swap_b32 v28, v25
  v_add_f32 v27, v27, v24
  v_add_f32 v28, v28, v25
  v_mul_f32 v27, v27, v26
  v_mul_f32 v28, v28, v26
  v_cvt_pk_bf16_f32 v137, v27, v28
  ds_bpermute_b32 v56, v16, v137 offset:0
  ds_bpermute_b32 v57, v16, v137 offset:16
  ds_bpermute_b32 v58, v16, v137 offset:32
  ds_bpermute_b32 v59, v16, v137 offset:48
  ds_bpermute_b32 v60, v16, v137 offset:64
  ds_bpermute_b32 v61, v16, v137 offset:80
  ds_bpermute_b32 v62, v16, v137 offset:96
  ds_bpermute_b32 v63, v16, v137 offset:112
  ds_bpermute_b32 v64, v21, v137 offset:0
  ds_bpermute_b32 v65, v21, v137 offset:64
  s_waitcnt lgkmcnt(9)
  v_perm_b32 v56, v56, v56, v3
  v_and_b32 v66, v56, v140
  v_and_b32 v67, v56, v141
  v_and_b32 v68, v56, v142
  v_and_b32 v69, v56, v143
  s_nop 1
  v_mfma_f32_16x16x32_bf16 v[40:43], v[76:79], v[66:69], v[40:43]
  s_waitcnt lgkmcnt(8)
  v_perm_b32 v57, v57, v57, v3
  v_and_b32 v70, v57, v140
  v_and_b32 v71, v57, v141
  v_and_b32 v72, v57, v142
  v_and_b32 v73, v57, v143
  s_nop 1
  v_mfma_f32_16x16x32_bf16 v[40:43], v[80:83], v[70:73], v[40:43]
  s_waitcnt lgkmcnt(7)
  v_perm_b32 v58, v58, v58, v3
  v_and_b32 v66, v58, v140
  v_and_b32 v67, v58, v141
  v_and_b32 v68, v58, v142
  v_and_b32 v69, v58, v143
  s_nop 1
  v_mfma_f32_16x16x32_bf16 v[40:43], v[84:87], v[66:69], v[40:43]
  s_waitcnt lgkmcnt(6)
  v_perm_b32 v59, v59, v59, v3
  v_and_b32 v70, v59, v140
  v_and_b32 v71, v59, v141
  v_and_b32 v72, v59, v142
  v_and_b32 v73, v59, v143
  s_nop 1
  v_mfma_f32_16x16x32_bf16 v[40:43], v[88:91], v[70:73], v[40:43]
  s_waitcnt lgkmcnt(5)
  v_perm_b32 v60, v60, v60, v3
  v_and_b32 v66, v60, v140
  v_and_b32 v67, v60, v141
  v_and_b32 v68, v60, v142
  v_and_b32 v69, v60, v143
  s_nop 1
  v_mfma_f32_16x16x32_bf16 v[40:43], v[92:95], v[66:69], v[40:43]
  s_waitcnt lgkmcnt(4)
  v_perm_b32 v61, v61, v61, v3
  v_and_b32 v70, v61, v140
  v_and_b32 v71, v61, v141
  v_and_b32 v72, v61, v142
  v_and_b32 v73, v61, v143
  s_nop 1
  v_mfma_f32_16x16x32_bf16 v[40:43], v[96:99], v[70:73], v[40:43]
  s_waitcnt lgkmcnt(3)
  v_perm_b32 v62, v62, v62, v3
  v_and_b32 v66, v62, v140
  v_and_b32 v67, v62, v141
  v_and_b32 v68, v62, v142
  v_and_b32 v69, v62, v143
  s_nop 1
  v_mfma_f32_16x16x32_bf16 v[40:43], v[100:103], v[66:69], v[40:43]
  s_waitcnt lgkmcnt(2)
  v_perm_b32 v63, v63, v63, v3
  v_and_b32 v70, v63, v140
  v_and_b32 v71, v63, v141
  v_and_b32 v72, v63, v142
  v_and_b32 v73, v63, v143
  s_nop 1
  v_mfma_f32_16x16x32_bf16 v[40:43], v[104:107], v[70:73], v[40:43]
  s_waitcnt lgkmcnt(1)
  v_perm_b32 v74, v64, v64, v6
  v_perm_b32 v64, v64, v64, v12
  v_dot2c_f32_bf16 v48, v108, v64
  v_dot2c_f32_bf16 v49, v108, v74
  v_dot2c_f32_bf16 v50, v109, v64
  v_dot2c_f32_bf16 v51, v109, v74
  v_dot2c_f32_bf16 v52, v110, v64
  v_dot2c_f32_bf16 v53, v110, v74
  v_dot2c_f32_bf16 v54, v111, v64
  v_dot2c_f32_bf16 v55, v111, v74
  s_waitcnt lgkmcnt(0)
  v_perm_b32 v75, v65, v65, v6
  v_perm_b32 v65, v65, v65, v12
  v_dot2c_f32_bf16 v48, v112, v65
  v_dot2c_f32_bf16 v49, v112, v75
  v_dot2c_f32_bf16 v50, v113, v65
  v_dot2c_f32_bf16 v51, v113, v75
  v_dot2c_f32_bf16 v52, v114, v65
  v_dot2c_f32_bf16 v53, v114, v75
  v_dot2c_f32_bf16 v54, v115, v65
  v_dot2c_f32_bf16 v55, v115, v75
  s_nop 2
  v_permlane32_swap_b32 v48, v52
  v_add_f32 v48, v48, v52
  v_permlane32_swap_b32 v50, v54
  v_add_f32 v50, v50, v54
  v_permlane32_swap_b32 v49, v53
  v_add_f32 v49, v49, v53
  v_permlane32_swap_b32 v51, v55
  v_add_f32 v51, v51, v55
  s_nop 0
  v_permlane16_swap_b32 v48, v50
  v_add_f32 v48, v48, v50
  v_permlane16_swap_b32 v49, v51
  v_add_f32 v49, v49, v51
  s_mov_b32 exec_lo, 0x00ff00ff
  s_mov_b32 exec_hi, 0xff00ff00
  ds_write2_b32 v13, v40, v41 offset0:0 offset1:8
  ds_write2_b32 v13, v42, v43 offset0:16 offset1:24
  s_mov_b64 exec, -1
  s_nop 0
  v_add_f32_dpp v48, v48, v48 row_ror:8 row_mask:0xf bank_mask:0xf
  v_add_f32_dpp v49, v49, v49 row_ror:8 row_mask:0xf bank_mask:0xf
  s_nop 0
  v_add_f32_dpp v48, v48, v48 row_ror:4 row_mask:0xf bank_mask:0xf
  v_add_f32_dpp v49, v49, v49 row_ror:4 row_mask:0xf bank_mask:0xf
  s_nop 0
  v_add_f32_dpp v48, v48, v48 quad_perm:[2,3,0,1] row_mask:0xf bank_mask:0xf
  v_add_f32_dpp v49, v49, v49 quad_perm:[2,3,0,1] row_mask:0xf bank_mask:0xf
  ds_write_b64 v14, v[48:49] offset:4864
  s_mov_b64 exec, 1
  ds_add_u32 v18, v30 offset:6160
  s_mov_b64 exec, -1
  s_cmp_lt_u32 s3, 27
  s_cbranch_scc1 L_fin
  s_cmp_eq_u32 s14, 1
  s_cbranch_scc0 L_fin
  v_mov_b32 v104, 0
  v_mov_b32 v105, s6
  v_mov_b32 v106, 0
  v_mov_b32 v107, s6
L_sp5:
  ds_read_b32 v28, v18 offset:6172
  s_waitcnt lgkmcnt(0)
  v_readfirstlane_b32 s7, v28
  s_nop 0
  s_cmp_ge_u32 s7, 1
  s_cbranch_scc1 L_sp5_ok
  s_sleep 1
  s_branch L_sp5
L_sp5_ok:
L_polly:
  buffer_load_dwordx4 v[92:95], v2, s[84:87], s15 offen offset:0 sc1
  buffer_load_dwordx4 v[96:99], v2, s[84:87], s15 offen offset:1024 sc1
  buffer_load_dwordx4 v[100:103], v2, s[84:87], s15 offen offset:2048 sc1
  s_mov_b32 exec_lo, 0xffffff
  s_mov_b32 exec_hi, 0
  buffer_load_dwordx4 v[104:107], v2, s[84:87], s15 offen offset:3072 sc1
  s_mov_b64 exec, -1
  s_add_u32 s11, s11, 65536
  s_waitcnt vmcnt(0)
  v_min3_u32 v24, v93, v95, v97
  v_min3_u32 v24, v24, v99, v101
  v_min3_u32 v24, v24, v103, v105
  v_min_u32 v24, v24, v107
  v_max3_u32 v25, v93, v95, v97
  v_max3_u32 v25, v25, v99, v101
  v_max3_u32 v25, v25, v103, v105
  v_max_u32 v25, v25, v107
  v_cmp_ne_u32 vcc, s6, v24
  v_cmp_ne_u32 s[12:13], s6, v25
  s_or_b64 vcc, vcc, s[12:13]
  s_cmp_gt_u32 s11, 0x7f000000
  s_cbranch_scc1 L_polly_done
  s_cbranch_vccnz L_polly
L_polly_done:
  v_add_f32 v118, v92, v96
  v_add_f32 v119, v94, v98
  v_add_f32 v26, v100, v104
  v_add_f32 v27, v102, v106
  v_add_f32 v118, v118, v26
  v_add_f32 v119, v119, v27
  s_nop 1
  v_permlane32_swap_b32 v118, v119
  v_add_f32 v118, v118, v119
  v_mov_b32 v27, v118
  s_nop 1
  v_permlane16_swap_b32 v118, v27
  v_add_f32 v118, v118, v27
  s_nop 1
  v_add_f32_dpp v118, v118, v118 row_ror:8 row_mask:0xf bank_mask:0xf
  v_lshrrev_b32 v28, 5, v1
  v_lshlrev_b32 v28, 4, v28
  v_lshrrev_b32 v136, v28, v136
  v_lshlrev_b32 v136, 16, v136
  v_lshrrev_b32 v23, v28, v23
  v_lshlrev_b32 v23, 16, v23
  v_cvt_pk_bf16_f32 v118, v118, v118
  v_and_b32 v118, 0xffff0000, v118
  v_add_f32 v118, v118, v136
  v_cvt_pk_bf16_f32 v118, v118, v118
  v_and_b32 v118, 0xffff0000, v118
  v_mul_f32 v26, s37, v118
  v_sub_f32 v26, 0, v26
  v_exp_f32 v26, v26
  s_nop 0
  v_add_f32 v26, 1.0, v26
  v_rcp_f32 v26, v26
  s_nop 0
  v_mul_f32 v118, v118, v26
  v_cvt_pk_bf16_f32 v118, v118, v118
  v_and_b32 v118, 0xffff0000, v118
  v_lshrrev_b32 v28, 5, v1
  v_lshl_add_u32 v7, v28, 1, v7
L_pollf:
  buffer_load_dwordx4 v[76:79], v2, s[84:87], s24 offen offset:0 sc1
  buffer_load_dwordx4 v[80:83], v2, s[84:87], s24 offen offset:1024 sc1
  buffer_load_dwordx4 v[84:87], v2, s[84:87], s24 offen offset:2048 sc1
  buffer_load_dwordx4 v[88:91], v2, s[84:87], s24 offen offset:3072 sc1
  s_add_u32 s11, s11, 65536
  s_waitcnt vmcnt(0)
  v_min3_u32 v24, v77, v79, v81
  v_min3_u32 v24, v24, v83, v85
  v_min3_u32 v24, v24, v87, v89
  v_min_u32 v24, v24, v91
  v_max3_u32 v25, v77, v79, v81
  v_max3_u32 v25, v25, v83, v85
  v_max3_u32 v25, v25, v87, v89
  v_max_u32 v25, v25, v91
  v_cmp_ne_u32 vcc, s6, v24
  v_cmp_ne_u32 s[12:13], s6, v25
  s_or_b64 vcc, vcc, s[12:13]
  v_add_f32 v116, v76, v80
  v_add_f32 v117, v78, v82
  v_add_f32 v26, v84, v88
  v_add_f32 v27, v86, v90
  v_add_f32 v116, v116, v26
  v_add_f32 v117, v117, v27
  s_cmp_gt_u32 s11, 0x7f000000
  s_cbranch_scc1 L_pollf_done
  s_cbranch_vccnz L_pollf
L_pollf_done:
  v_permlane32_swap_b32 v116, v117
  v_add_f32 v116, v116, v117
  v_mov_b32 v26, v116
  s_nop 1
  v_permlane16_swap_b32 v116, v26
  v_add_f32 v116, v116, v26
  s_nop 1
  v_add_f32_dpp v116, v116, v116 row_ror:8 row_mask:0xf bank_mask:0xf
  v_cvt_pk_bf16_f32 v116, v116, v116
  v_and_b32 v116, 0xffff0000, v116
  v_mul_f32 v116, v116, v118
  v_cvt_pk_bf16_f32 v116, v116, v116
  v_and_b32 v116, 0xffff0000, v116
  v_add_f32 v116, v116, v23
  v_cvt_pk_bf16_f32 v116, v116, v116
  s_mov_b32 exec_lo, 0xff
  s_mov_b32 exec_hi, 0xff
  buffer_store_short v116, v7, s[80:83], s38 offen
  s_cmp_eq_u32 s38, 0
  s_cbranch_scc0 L_fin0
  v_mov_b32 v26, s6
  s_mov_b64 exec, 1
  buffer_store_dword v26, v18, s[84:87], 0 offen sc1
L_fin0:
  s_mov_b64 exec, -1
  s_branch L_fin
L_kv:
  s_load_dwordx2 s[48:49], s[0:1], 8
  s_load_dwordx2 s[52:53], s[0:1], 16
  s_mov_b32 s50, 33554432
  s_mov_b32 s51, 0x20000
  s_mov_b32 s54, 33554432
  s_mov_b32 s55, 0x20000
  s_mov_b32 s86, 1544192
  s_mov_b32 s87, 0x20000
  s_sub_u32 s14, s5, 4
  s_lshl_b32 s21, s3, 20
  s_lshl_b32 s9, s4, 15
  s_add_u32 s21, s21, s9
  s_lshl_b32 s9, s14, 12
  s_add_u32 s21, s21, s9
  s_add_u32 s21, s21, 786432
  v_and_b32 v27, 7, v1
  v_lshlrev_b32 v10, 5, v24
  v_add_lshl_u32 v10, v10, v27, 2
  s_lshl_b32 s7, s14, 9
  v_add_u32 v10, s7, v10
  v_add_u32 v10, 0, v10
  v_and_b32 v140, 1, v27
  v_mov_b32 v141, 0xffff
  v_mov_b32 v142, 0xffff0000
  v_cmp_eq_u32 vcc, 0, v140
  v_lshrrev_b32 v26, 1, v27
  s_nop 0
  v_cndmask_b32 v28, v142, v141, vcc
  v_cmp_eq_u32 vcc, 0, v26
  v_cmp_eq_u32 s[12:13], 1, v26
  s_nop 1
  v_cndmask_b32 v140, 0, v28, vcc
  v_cndmask_b32 v141, 0, v28, s[12:13]
  v_cmp_eq_u32 vcc, 2, v26
  v_cmp_eq_u32 s[12:13], 3, v26
  s_nop 1
  v_cndmask_b32 v142, 0, v28, vcc
  v_cndmask_b32 v143, 0, v28, s[12:13]
  v_lshlrev_b32 v12, 4, v25
  v_lshrrev_b32 v21, 2, v1
  v_lshlrev_b32 v21, 2, v21
  s_lshl_b32 s7, s14, 6
  v_add_u32 v21, s7, v21
  s_mov_b32 s36, 0x3db504f3
  s_mov_b32 s12, 0x00010001
  s_mov_b32 s13, 0x00010001
  s_waitcnt lgkmcnt(0)
  s_barrier
  buffer_load_dwordx4 v[72:75], v2, s[48:51], s21 offen offset:0 nt
  buffer_load_dwordx4 v[76:79], v2, s[48:51], s21 offen offset:1024 nt
  buffer_load_dwordx4 v[80:83], v2, s[48:51], s21 offen offset:2048 nt
  buffer_load_dwordx4 v[84:87], v2, s[48:51], s21 offen offset:3072 nt
  s_barrier
  buffer_load_dwordx4 v[88:91], v2, s[52:55], s21 offen offset:0 nt
  buffer_load_dwordx4 v[92:95], v2, s[52:55], s21 offen offset:1024 nt
  buffer_load_dwordx4 v[96:99], v2, s[52:55], s21 offen offset:2048 nt
  buffer_load_dwordx4 v[100:103], v2, s[52:55], s21 offen offset:3072 nt
  s_waitcnt vmcnt(4)
  v_mov_b32 v52, 0
  v_mov_b32 v53, 0
  v_mov_b32 v54, 0
  v_mov_b32 v55, 0
  v_mov_b32 v40, 0
  v_mov_b32 v41, 0
  v_mov_b32 v42, 0
  v_mov_b32 v43, 0
  v_mov_b32 v44, 0
  v_mov_b32 v45, 0
  v_mov_b32 v46, 0
  v_mov_b32 v47, 0
  s_barrier
  s_barrier
  s_barrier
L_wq:
  ds_read_b32 v28, v18 offset:6144
  ds_read_b128 v[48:51], v12 offset:4096
  s_waitcnt lgkmcnt(0)
  v_readfirstlane_b32 s7, v28
  s_nop 0
  s_cmp_eq_u32 s7, 0
  s_cbranch_scc0 L_wq_ok
  s_sleep 1
  s_branch L_wq
L_wq_ok:
  s_setprio 2
  v_dot2c_f32_bf16 v52, v72, v48
  v_dot2c_f32_bf16 v53, v76, v48
  v_dot2c_f32_bf16 v54, v80, v48
  v_dot2c_f32_bf16 v55, v84, v48
  v_dot2c_f32_bf16 v52, v73, v49
  v_dot2c_f32_bf16 v53, v77, v49
  v_dot2c_f32_bf16 v54, v81, v49
  v_dot2c_f32_bf16 v55, v85, v49
  v_dot2c_f32_bf16 v52, v74, v50
  v_dot2c_f32_bf16 v53, v78, v50
  v_dot2c_f32_bf16 v54, v82, v50
  v_dot2c_f32_bf16 v55, v86, v50
  v_dot2c_f32_bf16 v52, v75, v51
  v_dot2c_f32_bf16 v53, v79, v51
  v_dot2c_f32_bf16 v54, v83, v51
  v_dot2c_f32_bf16 v55, v87, v51
  s_nop 2
  v_add_f32_dpp v24, v52, v52 row_ror:8 row_mask:0xf bank_mask:0x3
  v_add_f32_dpp v25, v53, v53 row_ror:8 row_mask:0xf bank_mask:0x3
  v_add_f32_dpp v24, v54, v54 row_ror:8 row_mask:0xf bank_mask:0xc
  v_add_f32_dpp v25, v55, v55 row_ror:8 row_mask:0xf bank_mask:0xc
  s_nop 0
  v_add_f32_dpp v26, v24, v24 row_shl:4 row_mask:0xf bank_mask:0x5
  v_add_f32_dpp v26, v25, v25 row_shr:4 row_mask:0xf bank_mask:0xa
  s_nop 1
  v_add_f32_dpp v26, v26, v26 quad_perm:[2,3,0,1] row_mask:0xf bank_mask:0xf
  s_nop 1
  v_add_f32_dpp v26, v26, v26 quad_perm:[1,0,3,2] row_mask:0xf bank_mask:0xf
  v_cvt_pk_bf16_f32 v26, v26, v26
  v_and_b32 v26, 0xffff0000, v26
  v_mul_f32 v26, s36, v26
  v_cvt_pk_bf16_f32 v26, v26, v26
  v_and_b32 v26, 0xffff0000, v26
  s_nop 1
  v_max_f32_dpp v24, v26, v26 row_ror:8 row_mask:0xf bank_mask:0xf
  s_nop 1
  v_max_f32_dpp v24, v24, v24 row_ror:4 row_mask:0xf bank_mask:0xf
  s_mov_b64 exec, s[12:13]
  ds_max_f32 v18, v24 offset:6168
  s_mov_b64 exec, 1
  ds_add_u32 v18, v30 offset:6148
  s_mov_b64 exec, -1
L_wm:
  ds_read_b32 v28, v18 offset:6148
  ds_read_b32 v56, v18 offset:6168
  s_waitcnt lgkmcnt(0)
  v_readfirstlane_b32 s7, v28
  v_sub_f32 v24, v26, v56
  s_cmp_lt_u32 s7, 8
  s_cbranch_scc1 L_wm
  v_mul_f32 v24, s37, v24
  v_exp_f32 v24, v24
  s_nop 0
  v_cvt_pk_bf16_f32 v58, v24, v24
  ds_write_b32 v21, v24 offset:4352
  s_mov_b64 exec, 1
  ds_add_u32 v18, v30 offset:6152
  s_mov_b64 exec, -1
  v_and_b32_dpp v60, v58, v140 row_newbcast:0 row_mask:0xf bank_mask:0xf
  v_and_b32_dpp v61, v58, v141 row_newbcast:0 row_mask:0xf bank_mask:0xf
  v_and_b32_dpp v62, v58, v142 row_newbcast:0 row_mask:0xf bank_mask:0xf
  v_and_b32_dpp v63, v58, v143 row_newbcast:0 row_mask:0xf bank_mask:0xf
  s_waitcnt vmcnt(3)
  s_nop 0
  v_mfma_f32_16x16x32_bf16 v[40:43], v[88:91], v[60:63], v[40:43]
  v_and_b32_dpp v64, v58, v140 row_newbcast:4 row_mask:0xf bank_mask:0xf
  v_and_b32_dpp v65, v58, v141 row_newbcast:4 row_mask:0xf bank_mask:0xf
  v_and_b32_dpp v66, v58, v142 row_newbcast:4 row_mask:0xf bank_mask:0xf
  v_and_b32_dpp v67, v58, v143 row_newbcast:4 row_mask:0xf bank_mask:0xf
  s_waitcnt vmcnt(2)
  s_nop 0
  v_mfma_f32_16x16x32_bf16 v[40:43], v[92:95], v[64:67], v[40:43]
  v_and_b32_dpp v60, v58, v140 row_newbcast:8 row_mask:0xf bank_mask:0xf
  v_and_b32_dpp v61, v58, v141 row_newbcast:8 row_mask:0xf bank_mask:0xf
  v_and_b32_dpp v62, v58, v142 row_newbcast:8 row_mask:0xf bank_mask:0xf
  v_and_b32_dpp v63, v58, v143 row_newbcast:8 row_mask:0xf bank_mask:0xf
  s_waitcnt vmcnt(1)
  s_nop 0
  v_mfma_f32_16x16x32_bf16 v[40:43], v[96:99], v[60:63], v[40:43]
  v_and_b32_dpp v64, v58, v140 row_newbcast:12 row_mask:0xf bank_mask:0xf
  v_and_b32_dpp v65, v58, v141 row_newbcast:12 row_mask:0xf bank_mask:0xf
  v_and_b32_dpp v66, v58, v142 row_newbcast:12 row_mask:0xf bank_mask:0xf
  v_and_b32_dpp v67, v58, v143 row_newbcast:12 row_mask:0xf bank_mask:0xf
  s_waitcnt vmcnt(0)
  s_nop 0
  v_mfma_f32_16x16x32_bf16 v[40:43], v[100:103], v[64:67], v[40:43]
  s_nop 7
  ds_write2_b32 v10, v40, v41 offset0:0 offset1:8
  ds_write2_b32 v10, v42, v43 offset0:16 offset1:24
  s_mov_b64 exec, 1
  ds_add_u32 v18, v30 offset:6156
  s_mov_b64 exec, -1
L_fin:
L_end:
  s_endpgm

.section .rodata,"a"
.p2align 6
.amdhsa_kernel recurrent_scan__sliding_block_cached__dense_activation_gelu__decode_kernel
  .amdhsa_next_free_vgpr 168
  .amdhsa_next_free_sgpr 102
  .amdhsa_accum_offset 168
  .amdhsa_group_segment_fixed_size 0
  .amdhsa_kernarg_size 104
  .amdhsa_user_sgpr_count 2
  .amdhsa_user_sgpr_kernarg_segment_ptr 1
  .amdhsa_system_sgpr_workgroup_id_x 1
.end_amdhsa_kernel
```
